```python
import torch

def _softmax(x, axis=-1):
    return torch.softmax(x, dim=axis)
def _gelu(x):
    return torch.nn.functional.gelu(x, approximate="tanh")
def _silu(x):
    return torch.nn.functional.silu(x)
def _sigmoid(x):
    return torch.sigmoid(x)
def _layernorm(x, axis=-1, eps=1e-5):
    m = x.mean(dim=axis, keepdim=True)
    v = x.var(dim=axis, keepdim=True, unbiased=False)
    return (x - m) / torch.sqrt(v + eps)
def _scatter_add(tgt, idx, src, axis=0):
    return tgt.clone().index_add_(axis, idx, src)
def _segment_sum(src, seg, n):
    out = torch.zeros((n,) + src.shape[1:], dtype=src.dtype)
    return out.index_add_(0, seg, src)
def _pad(x, pw):
    flat = tuple(v for pair in reversed(pw) for v in pair)
    return torch.nn.functional.pad(x, flat)

kernel_name = 'interleave_layers__sliding_block_cached__glu_gated_glu__decode'

def setup_inputs():

    _w = (lambda a: (lambda t: t.to(torch.bfloat16) if t.is_floating_point() else t)(torch.as_tensor(a)))
    def _A_setup():
        B, Sq, D = 8, 1, 512
        Hq, Hkv, Sk, Dh = 32, 8, 8192, 128
        assert Hq % Hkv == 0, (Hq, Hkv)
        return {
            "x": _w((lambda *s: torch.randn(*s, dtype=torch.bfloat16) * 0.05)(B, Sq, D)),
            "k_cache": _w((lambda *s: torch.randn(*s, dtype=torch.bfloat16) * 1.6)(B, Hkv, Sk, Dh)),
            "v_cache": _w((lambda *s: torch.randn(*s, dtype=torch.bfloat16) * 1.6)(B, Hkv, Sk, Dh)),
            "wq": _w((lambda *s: torch.randn(*s, dtype=torch.bfloat16) * 1.6)(D, Hq * Dh) * (D ** -0.5)),
            "wo": _w((lambda *s: torch.randn(*s, dtype=torch.bfloat16) * 1.6)(Hq * Dh, D) * ((Hq * Dh) ** -0.5)),
        }
    _A_in = _A_setup()

    def _B_setup():
        B, S, D, F = 8, 1, 512, 1792
        return {
            "x": _w((lambda *s: torch.randn(*s, dtype=torch.bfloat16) * 0.05)(B, S, D)),
            "w_gate": _w((lambda *s: torch.randn(*s, dtype=torch.bfloat16) * 0.05)(D, F)),
            "w_up": _w((lambda *s: torch.randn(*s, dtype=torch.bfloat16) * 0.05)(D, F)),
            "w_down": _w((lambda *s: torch.randn(*s, dtype=torch.bfloat16) * 0.05)(F, D)),
        }
    _B_in = _B_setup()

    return {
        "A_x": _A_in["x"],
        "A_k_cache": _A_in["k_cache"],
        "A_v_cache": _A_in["v_cache"],
        "A_wq": _A_in["wq"],
        "A_wo": _A_in["wo"],
        "B_x": _B_in["x"],
        "B_w_gate": _B_in["w_gate"],
        "B_w_up": _B_in["w_up"],
        "B_w_down": _B_in["w_down"],
    }

def reference(A_x, A_k_cache, A_v_cache, A_wq, A_wo, B_x, B_w_gate, B_w_up, B_w_down):
    def _A_ref(x, k_cache, v_cache, wq, wo):
        B, Sq, D = x.shape
        Hq, Dh = 32, 128
        Hkv, Sk = k_cache.shape[1], k_cache.shape[2]
        W = min(4096, max(256, Sk // 4))
        rep = Hq // Hkv
        q = (lambda x, *d: x.permute(*d))((x @ wq).reshape(B, Sq, Hq, Dh), 0, 2, 1, 3)
        k = (lambda x, n, axis: torch.repeat_interleave(x, n, dim=axis))(k_cache[:, :, Sk - W:, :], rep, axis=1)
        v = (lambda x, n, axis: torch.repeat_interleave(x, n, dim=axis))(v_cache[:, :, Sk - W:, :], rep, axis=1)
        scores = torch.einsum("bhqd,bhkd->bhqk", q, k) * (Dh ** -0.5)
        p = _softmax(scores, axis=-1)
        o = torch.einsum("bhqk,bhkd->bhqd", p, v)
        return (lambda x, *d: x.permute(*d))(o, 0, 2, 1, 3).reshape(B, Sq, Hq * Dh) @ wo

    def _B_ref(x, w_gate, w_up, w_down):
        g = torch.einsum("bsd,df->bsf", x, w_gate)
        u = torch.einsum("bsd,df->bsf", x, w_up)
        h = _sigmoid(g) * u
        return torch.einsum("bsf,fd->bsd", h, w_down)

    x = A_x
    x = x + _A_ref(_layernorm(x, axis=-1), A_k_cache, A_v_cache, A_wq, A_wo)
    x = x + _B_ref(_layernorm(x, axis=-1), B_w_gate, B_w_up, B_w_down)
    x = x + _A_ref(_layernorm(x, axis=-1), A_k_cache, A_v_cache, A_wq, A_wo)
    x = x + _B_ref(_layernorm(x, axis=-1), B_w_gate, B_w_up, B_w_down)
    return x
```

```asm
; @launch grid=(256,1,1) block=(512,1,1) lds=157184
.amdgcn_target "amdgcn-amd-amdhsa--gfx950"
.text
.globl interleave_layers__sliding_block_cached__glu_gated_glu__decode_kernel
.p2align 8
.type interleave_layers__sliding_block_cached__glu_gated_glu__decode_kernel,@function
interleave_layers__sliding_block_cached__glu_gated_glu__decode_kernel:
s_cmp_ge_u32 s2, 256
s_cbranch_scc1 L_END
s_load_dwordx16 s[8:23], s[0:1], 0
s_load_dwordx8 s[24:31], s[0:1], 64
s_memrealtime s[94:95]
v_and_b32 v1, 63, v0
v_lshrrev_b32 v44, 6, v0
s_nop 0
v_readfirstlane_b32 s3, v44
v_and_b32 v47, 15, v1
v_lshrrev_b32 v48, 4, v1
s_cmp_eq_u32 s3, 1
s_cbranch_scc0 L_pf_1
s_getpc_b64 s[84:85]
v_lshlrev_b32 v52, 6, v1
global_load_dword v53, v52, s[84:85]
s_add_u32 s84, s84, 4096
s_addc_u32 s85, s85, 0
global_load_dword v53, v52, s[84:85]
s_add_u32 s84, s84, 4096
s_addc_u32 s85, s85, 0
global_load_dword v53, v52, s[84:85]
s_add_u32 s84, s84, 4096
s_addc_u32 s85, s85, 0
global_load_dword v53, v52, s[84:85]
s_add_u32 s84, s84, 4096
s_addc_u32 s85, s85, 0
global_load_dword v53, v52, s[84:85]
s_add_u32 s84, s84, 4096
s_addc_u32 s85, s85, 0
L_pf_1:
s_and_b32 s4, s2, 7
s_lshr_b32 s5, s2, 3
s_lshr_b32 s6, s5, 2
s_and_b32 s7, s5, 3
s_and_b32 s98, s5, 7
s_lshl_b32 s98, s98, 2
s_add_u32 s98, s98, s3
v_xor_b32 v49, v47, v48
v_lshlrev_b32 v49, 4, v49
v_lshl_add_u32 v32, v48, 8, v49
v_xor_b32 v33, 64, v32
v_xor_b32 v34, 128, v32
v_xor_b32 v35, 192, v32
s_add_u32 s89, s3, 1
s_lshl_b32 s89, s89, 13
s_cmp_eq_u32 s3, 0
s_cselect_b32 s89, 0, s89
s_mul_i32 s87, s5, 3
s_add_u32 s87, s87, s3
s_and_b32 s60, s87, 31
s_lshl_b32 s60, s60, 12
s_lshl_b32 s86, s6, 3
s_add_u32 s86, s86, s4
s_lshl_b32 s86, s86, 21
s_lshl_b32 s85, s7, 17
s_add_u32 s86, s86, s85
s_add_u32 s86, s86, 0x180000
s_waitcnt lgkmcnt(0)
s_add_u32 s32, s10, s86
s_addc_u32 s33, s11, 0
s_mov_b32 s34, 0x20000
s_mov_b32 s35, 0x20000
s_cmp_eq_u32 s3, 0
s_cbranch_scc0 L_w0s_2
s_cmp_eq_u32 s2, 0
s_cbranch_scc0 L_nolead_3
s_mov_b32 s48, s28
s_mov_b32 s49, s29
s_mov_b32 s50, 0x100
s_mov_b32 s51, 0x20000
s_lshl_b32 s94, s94, 4
s_or_b32 s94, s94, 0x80000000
v_mov_b32 v251, s94
v_mov_b32 v250, 0
s_mov_b64 exec, 1
buffer_store_dword v251, v250, s[48:51], 0 offen sc1
s_mov_b64 exec, -1
L_nolead_3:
s_lshl_b32 s84, s4, 10
s_lshl_b32 s85, s5, 5
s_add_u32 s84, s84, s85
s_sub_u32 s85, 0x400000, s84
s_add_u32 s48, s14, s84
s_addc_u32 s49, s15, 0
s_mov_b32 s50, s85
s_mov_b32 s51, 0x20000
s_mov_b32 s52, s8
s_mov_b32 s53, s9
s_mov_b32 s54, 0x2000
s_mov_b32 s55, 0x20000
v_lshrrev_b32 v51, 1, v1
v_and_b32 v50, 1, v1
v_lshlrev_b32 v50, 4, v50
v_lshl_add_u32 v51, v51, 13, v50
v_xor_b32 v52, 0, v1
v_lshlrev_b32 v52, 4, v52
s_mov_b32 m0, 8192
s_mov_b32 s85, 0
buffer_load_dwordx4 v52, s[52:55], s85 offen lds
v_xor_b32 v52, 1, v1
v_lshlrev_b32 v52, 4, v52
s_mov_b32 m0, 9216
s_mov_b32 s85, 1024
buffer_load_dwordx4 v52, s[52:55], s85 offen lds
v_xor_b32 v52, 2, v1
v_lshlrev_b32 v52, 4, v52
s_mov_b32 m0, 10240
s_mov_b32 s85, 2048
buffer_load_dwordx4 v52, s[52:55], s85 offen lds
v_xor_b32 v52, 3, v1
v_lshlrev_b32 v52, 4, v52
s_mov_b32 m0, 11264
s_mov_b32 s85, 3072
buffer_load_dwordx4 v52, s[52:55], s85 offen lds
v_xor_b32 v52, 4, v1
v_lshlrev_b32 v52, 4, v52
s_mov_b32 m0, 12288
s_mov_b32 s85, 4096
buffer_load_dwordx4 v52, s[52:55], s85 offen lds
v_xor_b32 v52, 5, v1
v_lshlrev_b32 v52, 4, v52
s_mov_b32 m0, 13312
s_mov_b32 s85, 5120
buffer_load_dwordx4 v52, s[52:55], s85 offen lds
v_xor_b32 v52, 6, v1
v_lshlrev_b32 v52, 4, v52
s_mov_b32 m0, 14336
s_mov_b32 s85, 6144
buffer_load_dwordx4 v52, s[52:55], s85 offen lds
v_xor_b32 v52, 7, v1
v_lshlrev_b32 v52, 4, v52
s_mov_b32 m0, 15360
s_mov_b32 s85, 7168
buffer_load_dwordx4 v52, s[52:55], s85 offen lds
s_mov_b32 m0, 139264
s_mov_b32 s85, 0
buffer_load_dwordx4 v51, s[48:51], s85 offen nt lds
s_mov_b32 m0, 140288
s_mov_b32 s85, 262144
buffer_load_dwordx4 v51, s[48:51], s85 offen nt lds
s_mov_b32 m0, 141312
s_mov_b32 s85, 524288
buffer_load_dwordx4 v51, s[48:51], s85 offen nt lds
s_mov_b32 m0, 142336
s_mov_b32 s85, 786432
buffer_load_dwordx4 v51, s[48:51], s85 offen nt lds
s_mov_b32 m0, 143360
s_mov_b32 s85, 1048576
buffer_load_dwordx4 v51, s[48:51], s85 offen nt lds
s_mov_b32 m0, 144384
s_mov_b32 s85, 1310720
buffer_load_dwordx4 v51, s[48:51], s85 offen nt lds
s_mov_b32 m0, 145408
s_mov_b32 s85, 1572864
buffer_load_dwordx4 v51, s[48:51], s85 offen nt lds
s_mov_b32 m0, 146432
s_mov_b32 s85, 1835008
buffer_load_dwordx4 v51, s[48:51], s85 offen nt lds
s_mov_b32 m0, 147456
s_mov_b32 s85, 2097152
buffer_load_dwordx4 v51, s[48:51], s85 offen nt lds
s_mov_b32 m0, 148480
s_mov_b32 s85, 2359296
buffer_load_dwordx4 v51, s[48:51], s85 offen nt lds
s_mov_b32 m0, 149504
s_mov_b32 s85, 2621440
buffer_load_dwordx4 v51, s[48:51], s85 offen nt lds
s_mov_b32 m0, 150528
s_mov_b32 s85, 2883584
buffer_load_dwordx4 v51, s[48:51], s85 offen nt lds
s_mov_b32 m0, 151552
s_mov_b32 s85, 3145728
buffer_load_dwordx4 v51, s[48:51], s85 offen nt lds
s_mov_b32 m0, 152576
s_mov_b32 s85, 3407872
buffer_load_dwordx4 v51, s[48:51], s85 offen nt lds
s_mov_b32 m0, 153600
s_mov_b32 s85, 3670016
buffer_load_dwordx4 v51, s[48:51], s85 offen nt lds
s_mov_b32 m0, 154624
s_mov_b32 s85, 3932160
buffer_load_dwordx4 v51, s[48:51], s85 offen nt lds
L_w0s_2:
s_add_u32 m0, s89, 0
s_nop 0
buffer_load_dwordx4 v32, s[32:35], s60 offen offset:0 nt lds
buffer_load_dwordx4 v33, s[32:35], s60 offen offset:1024 nt lds
buffer_load_dwordx4 v34, s[32:35], s60 offen offset:2048 nt lds
buffer_load_dwordx4 v35, s[32:35], s60 offen offset:3072 nt lds
v_mov_b32 v45, 156928
v_mov_b32 v46, 0
ds_write_b32 v45, v46
ds_write_b32 v45, v46 offset:12
ds_write_b32 v45, v46 offset:16
s_add_u32 s61, s87, 8
s_and_b32 s61, s61, 31
s_lshl_b32 s61, s61, 12
s_add_u32 s62, s87, 16
s_and_b32 s62, s62, 31
s_lshl_b32 s62, s62, 12
s_add_u32 s63, s87, 24
s_and_b32 s63, s63, 31
s_lshl_b32 s63, s63, 12
v_lshlrev_b32 v49, 1, v48
v_xor_b32 v49, v47, v49
v_lshlrev_b32 v49, 4, v49
v_lshl_add_u32 v36, v48, 8, v49
v_xor_b32 v37, 0x80, v36
s_waitcnt lgkmcnt(0)
s_barrier
s_add_u32 s36, s12, s86
s_addc_u32 s37, s13, 0
s_mov_b32 s38, 0x20000
s_mov_b32 s39, 0x20000
s_lshl_b32 s84, s4, 18
s_add_u32 s40, s30, s84
s_addc_u32 s41, s31, 0
s_mov_b32 s42, 0x40000
s_mov_b32 s43, 0x20000
s_add_u32 s44, s30, 0x200000
s_addc_u32 s45, s31, 0
s_mov_b32 s46, 0x100000
s_mov_b32 s47, 0x20000
s_mov_b32 s58, 0x20000
s_mov_b32 s64, 0x00ff00ff
s_mov_b32 s65, 0x00ff00ff
s_mov_b32 s66, 0xff00ff00
s_mov_b32 s67, 0xff00ff00
s_sub_u32 s59, s3, 4
v_mov_b32 v250, 0
s_cmp_eq_u32 s3, 0
s_cbranch_scc1 L_pre0_4
v_mov_b32 v60, -1
v_mov_b32 v61, -1
v_mov_b32 v62, -1
v_mov_b32 v63, -1
s_mul_i32 s84, s5, 7168
s_lshl_b32 s85, s3, 10
s_add_u32 s84, s84, s85
s_add_u32 s84, s84, 4294966272
v_lshl_add_u32 v49, v1, 4, s84
buffer_store_dwordx4 v[60:63], v49, s[40:43], 0 offen
s_cmp_lt_u32 s3, 4
s_cbranch_scc1 L_pre0_4
s_branch L_pree_5
L_pre0_4:
v_lshrrev_b32 v52, 3, v1
v_and_b32 v53, 7, v1
v_lshlrev_b32 v53, 2, v53
v_lshl_add_u32 v7, v52, 10, v53
s_lshl_b32 s84, s98, 5
v_add_u32 v7, s84, v7
s_mov_b32 s52, s8
s_mov_b32 s53, s9
s_mov_b32 s54, 0x2000
s_mov_b32 s55, 0x20000
buffer_load_dword v16, v7, s[52:55], 0 offen
L_pree_5:
v_and_b32 v47, 15, v1
v_lshrrev_b32 v48, 4, v1
s_mov_b32 s68, 0x3e0293ee
s_mov_b32 s69, 0x3b000000
s_mov_b32 s70, 0x3727c5ac
s_mov_b32 s71, 0xbfb8aa3b
v_mov_b32 v43, -2
v_mov_b32 v56, 0x3f803f80
v_mov_b32 v57, 0x3f803f80
v_mov_b32 v58, 0x3f803f80
v_mov_b32 v59, 0x3f803f80
v_xor_b32 v49, v47, v48
v_lshlrev_b32 v49, 4, v49
v_lshl_add_u32 v49, v47, 8, v49
v_add_u32 v38, s89, v49
v_xor_b32 v39, 64, v38
v_xor_b32 v40, 128, v38
v_xor_b32 v41, 192, v38
v_lshrrev_b32 v49, 2, v47
v_lshl_add_u32 v49, v48, 2, v49
v_and_b32 v50, 7, v49
v_lshlrev_b32 v50, 5, v50
v_lshl_add_u32 v50, v49, 8, v50
v_and_b32 v51, 3, v1
v_lshl_add_u32 v50, v51, 3, v50
v_add_u32 v42, s89, v50
v_and_b32 v52, 3, v47
v_xor_b32 v52, v48, v52
v_lshlrev_b32 v52, 4, v52
v_and_b32 v50, 4, v47
v_lshl_add_u32 v52, v50, 4, v52
v_and_b32 v50, 7, v47
v_lshl_add_u32 v52, v50, 10, v52
s_lshl_b32 s84, s59, 8
v_xor_b32 v55, s84, v52
v_lshrrev_b32 v49, 2, v47
v_lshl_add_u32 v49, v48, 3, v49
v_lshlrev_b32 v49, 5, v49
v_and_b32 v50, 3, v1
v_lshl_add_u32 v49, v50, 3, v49
s_lshl_b32 s84, s59, 12
s_add_u32 s84, s84, 139264
v_add_u32 v11, s84, v49
s_cmp_eq_u32 s3, 0
s_cbranch_scc0 L_NOTW0
s_mov_b32 s72, 0
s_mov_b32 s83, m0
s_mov_b32 s48, s28
s_mov_b32 s49, s29
s_mov_b32 s50, 0x100
s_mov_b32 s51, 0x20000
s_mov_b64 exec, 1
buffer_load_dword v251, v250, s[48:51], 0 offen sc1
s_mov_b64 exec, -1
s_mov_b32 m0, s83
s_add_u32 m0, s89, 4096
s_nop 0
buffer_load_dwordx4 v32, s[32:35], s61 offen offset:0 nt lds
buffer_load_dwordx4 v33, s[32:35], s61 offen offset:1024 nt lds
s_mov_b32 s83, m0
s_waitcnt vmcnt(2)
L_nonce_6:
v_readfirstlane_b32 s80, v251
s_nop 0
s_cmp_lg_u32 s80, 0
s_cbranch_scc1 L_nonce_ok_7
s_sleep 4
s_mov_b32 s48, s28
s_mov_b32 s49, s29
s_mov_b32 s50, 0x100
s_mov_b32 s51, 0x20000
s_mov_b64 exec, 1
buffer_load_dword v251, v250, s[48:51], 0 offen sc1
s_mov_b64 exec, -1
s_sub_u32 s58, s58, 1
s_cbranch_scc1 L_END
s_waitcnt vmcnt(0)
s_branch L_nonce_6
L_nonce_ok_7:
v_and_b32 v47, 15, v1
v_lshrrev_b32 v48, 4, v1
s_mov_b64 exec, s[66:67]
v_mov_b32 v128, v56
v_mov_b32 v129, v56
v_mov_b32 v130, v56
v_mov_b32 v131, v56
v_mov_b32 v132, v56
v_mov_b32 v133, v56
v_mov_b32 v134, v56
v_mov_b32 v135, v56
v_mov_b32 v136, v56
v_mov_b32 v137, v56
v_mov_b32 v138, v56
v_mov_b32 v139, v56
v_mov_b32 v140, v56
v_mov_b32 v141, v56
v_mov_b32 v142, v56
v_mov_b32 v143, v56
v_mov_b32 v144, v56
v_mov_b32 v145, v56
v_mov_b32 v146, v56
v_mov_b32 v147, v56
v_mov_b32 v148, v56
v_mov_b32 v149, v56
v_mov_b32 v150, v56
v_mov_b32 v151, v56
v_mov_b32 v152, v56
v_mov_b32 v153, v56
v_mov_b32 v154, v56
v_mov_b32 v155, v56
v_mov_b32 v156, v56
v_mov_b32 v157, v56
v_mov_b32 v158, v56
v_mov_b32 v159, v56
v_mov_b32 v160, v56
v_mov_b32 v161, v56
v_mov_b32 v162, v56
v_mov_b32 v163, v56
v_mov_b32 v164, v56
v_mov_b32 v165, v56
v_mov_b32 v166, v56
v_mov_b32 v167, v56
v_mov_b32 v168, v56
v_mov_b32 v169, v56
v_mov_b32 v170, v56
v_mov_b32 v171, v56
v_mov_b32 v172, v56
v_mov_b32 v173, v56
v_mov_b32 v174, v56
v_mov_b32 v175, v56
v_mov_b32 v176, v56
v_mov_b32 v177, v56
v_mov_b32 v178, v56
v_mov_b32 v179, v56
v_mov_b32 v180, v56
v_mov_b32 v181, v56
v_mov_b32 v182, v56
v_mov_b32 v183, v56
v_mov_b32 v184, v56
v_mov_b32 v185, v56
v_mov_b32 v186, v56
v_mov_b32 v187, v56
v_mov_b32 v188, v56
v_mov_b32 v189, v56
v_mov_b32 v190, v56
v_mov_b32 v191, v56
s_mov_b64 exec, s[64:65]
s_lshl_b32 s84, s59, 8
v_xor_b32 v52, s84, v55
v_xor_b32 v49, 0, v52
v_add_u32 v49, 8192, v49
ds_read_b128 v[128:131], v49
v_xor_b32 v50, 64, v52
v_add_u32 v50, 8192, v50
ds_read_b128 v[132:135], v50
v_xor_b32 v49, 128, v52
v_add_u32 v49, 8192, v49
ds_read_b128 v[136:139], v49
v_xor_b32 v50, 192, v52
v_add_u32 v50, 8192, v50
ds_read_b128 v[140:143], v50
v_xor_b32 v49, 256, v52
v_add_u32 v49, 8192, v49
ds_read_b128 v[144:147], v49
v_xor_b32 v50, 320, v52
v_add_u32 v50, 8192, v50
ds_read_b128 v[148:151], v50
v_xor_b32 v49, 384, v52
v_add_u32 v49, 8192, v49
ds_read_b128 v[152:155], v49
v_xor_b32 v50, 448, v52
v_add_u32 v50, 8192, v50
ds_read_b128 v[156:159], v50
v_xor_b32 v49, 512, v52
v_add_u32 v49, 8192, v49
ds_read_b128 v[160:163], v49
v_xor_b32 v50, 576, v52
v_add_u32 v50, 8192, v50
ds_read_b128 v[164:167], v50
v_xor_b32 v49, 640, v52
v_add_u32 v49, 8192, v49
ds_read_b128 v[168:171], v49
v_xor_b32 v50, 704, v52
v_add_u32 v50, 8192, v50
ds_read_b128 v[172:175], v50
v_xor_b32 v49, 768, v52
v_add_u32 v49, 8192, v49
ds_read_b128 v[176:179], v49
v_xor_b32 v50, 832, v52
v_add_u32 v50, 8192, v50
ds_read_b128 v[180:183], v50
v_xor_b32 v49, 896, v52
v_add_u32 v49, 8192, v49
ds_read_b128 v[184:187], v49
v_xor_b32 v50, 960, v52
v_add_u32 v50, 8192, v50
ds_read_b128 v[188:191], v50
s_mov_b64 exec, -1
s_lshl_b32 s84, s59, 12
v_subrev_u32 v53, s84, v11
ds_read_b64_tr_b16 v[208:209], v53 offset:0
ds_read_b64_tr_b16 v[210:211], v53 offset:128
ds_read_b64_tr_b16 v[212:213], v53 offset:1024
ds_read_b64_tr_b16 v[214:215], v53 offset:1152
ds_read_b64_tr_b16 v[216:217], v53 offset:2048
ds_read_b64_tr_b16 v[218:219], v53 offset:2176
ds_read_b64_tr_b16 v[220:221], v53 offset:3072
ds_read_b64_tr_b16 v[222:223], v53 offset:3200
ds_read_b64_tr_b16 v[224:225], v53 offset:4096
ds_read_b64_tr_b16 v[226:227], v53 offset:4224
ds_read_b64_tr_b16 v[228:229], v53 offset:5120
ds_read_b64_tr_b16 v[230:231], v53 offset:5248
ds_read_b64_tr_b16 v[232:233], v53 offset:6144
ds_read_b64_tr_b16 v[234:235], v53 offset:6272
ds_read_b64_tr_b16 v[236:237], v53 offset:7168
ds_read_b64_tr_b16 v[238:239], v53 offset:7296
s_waitcnt lgkmcnt(0)
v_mfma_f32_16x16x32_bf16 v[192:195], v[128:131], v[208:211], 0
v_mfma_f32_16x16x32_bf16 v[196:199], v[128:131], v[128:131], 0
v_mfma_f32_16x16x32_bf16 v[192:195], v[132:135], v[212:215], v[192:195]
v_mfma_f32_16x16x32_bf16 v[196:199], v[132:135], v[132:135], v[196:199]
v_mfma_f32_16x16x32_bf16 v[192:195], v[136:139], v[216:219], v[192:195]
v_mfma_f32_16x16x32_bf16 v[196:199], v[136:139], v[136:139], v[196:199]
v_mfma_f32_16x16x32_bf16 v[192:195], v[140:143], v[220:223], v[192:195]
v_mfma_f32_16x16x32_bf16 v[196:199], v[140:143], v[140:143], v[196:199]
v_mfma_f32_16x16x32_bf16 v[192:195], v[144:147], v[224:227], v[192:195]
v_mfma_f32_16x16x32_bf16 v[196:199], v[144:147], v[144:147], v[196:199]
v_mfma_f32_16x16x32_bf16 v[192:195], v[148:151], v[228:231], v[192:195]
v_mfma_f32_16x16x32_bf16 v[196:199], v[148:151], v[148:151], v[196:199]
v_mfma_f32_16x16x32_bf16 v[192:195], v[152:155], v[232:235], v[192:195]
v_mfma_f32_16x16x32_bf16 v[196:199], v[152:155], v[152:155], v[196:199]
v_mfma_f32_16x16x32_bf16 v[192:195], v[156:159], v[236:239], v[192:195]
v_mfma_f32_16x16x32_bf16 v[196:199], v[156:159], v[156:159], v[196:199]
s_nop 7
ds_read_b64_tr_b16 v[208:209], v53 offset:8192
ds_read_b64_tr_b16 v[210:211], v53 offset:8320
ds_read_b64_tr_b16 v[212:213], v53 offset:9216
ds_read_b64_tr_b16 v[214:215], v53 offset:9344
ds_read_b64_tr_b16 v[216:217], v53 offset:10240
ds_read_b64_tr_b16 v[218:219], v53 offset:10368
ds_read_b64_tr_b16 v[220:221], v53 offset:11264
ds_read_b64_tr_b16 v[222:223], v53 offset:11392
ds_read_b64_tr_b16 v[224:225], v53 offset:12288
ds_read_b64_tr_b16 v[226:227], v53 offset:12416
ds_read_b64_tr_b16 v[228:229], v53 offset:13312
ds_read_b64_tr_b16 v[230:231], v53 offset:13440
ds_read_b64_tr_b16 v[232:233], v53 offset:14336
ds_read_b64_tr_b16 v[234:235], v53 offset:14464
ds_read_b64_tr_b16 v[236:237], v53 offset:15360
ds_read_b64_tr_b16 v[238:239], v53 offset:15488
s_waitcnt lgkmcnt(0)
v_mfma_f32_16x16x32_bf16 v[192:195], v[160:163], v[208:211], v[192:195]
v_mfma_f32_16x16x32_bf16 v[196:199], v[160:163], v[160:163], v[196:199]
v_mfma_f32_16x16x32_bf16 v[192:195], v[164:167], v[212:215], v[192:195]
v_mfma_f32_16x16x32_bf16 v[196:199], v[164:167], v[164:167], v[196:199]
v_mfma_f32_16x16x32_bf16 v[192:195], v[168:171], v[216:219], v[192:195]
v_mfma_f32_16x16x32_bf16 v[196:199], v[168:171], v[168:171], v[196:199]
v_mfma_f32_16x16x32_bf16 v[192:195], v[172:175], v[220:223], v[192:195]
v_mfma_f32_16x16x32_bf16 v[196:199], v[172:175], v[172:175], v[196:199]
v_mfma_f32_16x16x32_bf16 v[192:195], v[176:179], v[224:227], v[192:195]
v_mfma_f32_16x16x32_bf16 v[196:199], v[176:179], v[176:179], v[196:199]
v_mfma_f32_16x16x32_bf16 v[192:195], v[180:183], v[228:231], v[192:195]
v_mfma_f32_16x16x32_bf16 v[196:199], v[180:183], v[180:183], v[196:199]
v_mfma_f32_16x16x32_bf16 v[192:195], v[184:187], v[232:235], v[192:195]
v_mfma_f32_16x16x32_bf16 v[196:199], v[184:187], v[184:187], v[196:199]
v_mfma_f32_16x16x32_bf16 v[192:195], v[188:191], v[236:239], v[192:195]
v_mfma_f32_16x16x32_bf16 v[196:199], v[188:191], v[188:191], v[196:199]
s_nop 7
v_mov_b32_dpp v200, v196 row_newbcast:8 row_mask:0xf bank_mask:0xf
v_mov_b32_dpp v201, v197 row_newbcast:8 row_mask:0xf bank_mask:0xf
v_mov_b32_dpp v202, v198 row_newbcast:8 row_mask:0xf bank_mask:0xf
v_mov_b32_dpp v203, v199 row_newbcast:8 row_mask:0xf bank_mask:0xf
v_mov_b32_dpp v204, v196 row_newbcast:0 row_mask:0xd bank_mask:0xf
s_nop 1
v_mov_b32_dpp v204, v196 row_newbcast:4 row_mask:0x2 bank_mask:0xf
v_mov_b32_dpp v205, v197 row_newbcast:1 row_mask:0xd bank_mask:0xf
s_nop 1
v_mov_b32_dpp v205, v197 row_newbcast:5 row_mask:0x2 bank_mask:0xf
v_mov_b32_dpp v206, v198 row_newbcast:2 row_mask:0xd bank_mask:0xf
s_nop 1
v_mov_b32_dpp v206, v198 row_newbcast:6 row_mask:0x2 bank_mask:0xf
v_mov_b32_dpp v207, v199 row_newbcast:3 row_mask:0xd bank_mask:0xf
s_nop 1
v_mov_b32_dpp v207, v199 row_newbcast:7 row_mask:0x2 bank_mask:0xf
v_mov_b32 v245, v192
v_mov_b32 v244, 0
s_nop 1
v_permlane32_swap_b32 v245, v244
v_mul_f32 v200, s69, v200
v_mul_f32 v204, s69, v204
v_fma_f32 v204, -v200, v200, v204
v_max_f32 v204, 0, v204
v_add_f32 v204, s70, v204
v_rsq_f32 v204, v204
v_fma_f32 v240, -v200, v244, v192
v_mul_f32 v240, v240, v204
v_mul_f32 v201, s69, v201
v_mul_f32 v205, s69, v205
v_fma_f32 v205, -v201, v201, v205
v_max_f32 v205, 0, v205
v_add_f32 v205, s70, v205
v_rsq_f32 v205, v205
v_fma_f32 v241, -v201, v244, v193
v_mul_f32 v241, v241, v205
v_mul_f32 v202, s69, v202
v_mul_f32 v206, s69, v206
v_fma_f32 v206, -v202, v202, v206
v_max_f32 v206, 0, v206
v_add_f32 v206, s70, v206
v_rsq_f32 v206, v206
v_fma_f32 v242, -v202, v244, v194
v_mul_f32 v242, v242, v206
v_mul_f32 v203, s69, v203
v_mul_f32 v207, s69, v207
v_fma_f32 v207, -v203, v203, v207
v_max_f32 v207, 0, v207
v_add_f32 v207, s70, v207
v_rsq_f32 v207, v207
v_fma_f32 v243, -v203, v244, v195
v_mul_f32 v243, v243, v207
v_mov_b32_dpp v200, v240 quad_perm:[1,0,3,2] row_mask:0xf bank_mask:0xf
v_mov_b32_dpp v201, v241 quad_perm:[1,0,3,2] row_mask:0xf bank_mask:0xf
v_mov_b32_dpp v202, v242 quad_perm:[1,0,3,2] row_mask:0xf bank_mask:0xf
v_mov_b32_dpp v203, v243 quad_perm:[1,0,3,2] row_mask:0xf bank_mask:0xf
v_cvt_pk_bf16_f32 v208, v240, v200
v_mov_b32 v209, s80
v_cvt_pk_bf16_f32 v210, v241, v201
v_mov_b32 v211, s80
v_cvt_pk_bf16_f32 v212, v242, v202
v_mov_b32 v213, s80
v_cvt_pk_bf16_f32 v214, v243, v203
v_mov_b32 v215, s80
v_lshrrev_b32 v53, 1, v47
v_lshlrev_b32 v53, 3, v53
v_lshl_add_u32 v53, v48, 8, v53
s_lshl_b32 s84, s5, 9
s_add_u32 s84, s84, 0x38000
s_mov_b32 exec_lo, 0x55555555
s_mov_b32 exec_hi, 0
buffer_store_dwordx2 v[208:209], v53, s[40:43], s84 offen offset:0 sc1
buffer_store_dwordx2 v[210:211], v53, s[40:43], s84 offen offset:64 sc1
buffer_store_dwordx2 v[212:213], v53, s[40:43], s84 offen offset:128 sc1
buffer_store_dwordx2 v[214:215], v53, s[40:43], s84 offen offset:192 sc1
s_mov_b64 exec, -1
s_mov_b32 m0, s83
s_nop 0
buffer_load_dwordx4 v34, s[32:35], s61 offen offset:2048 nt lds
buffer_load_dwordx4 v35, s[32:35], s61 offen offset:3072 nt lds
s_waitcnt vmcnt(7)
s_mov_b32 s83, m0
v_mov_b32 v48, 156928
L_cBw_8:
ds_read_b32 v49, v48 offset:12
s_sub_u32 s58, s58, 1
s_cbranch_scc1 L_END
s_waitcnt lgkmcnt(0)
v_cmp_ne_u32 vcc, 7, v49
s_cbranch_vccz L_spin_ok_9
s_sleep 1
s_branch L_cBw_8
L_spin_ok_9:
s_getreg_b32 s84, hwreg(HW_REG_XCC_ID, 0, 4)
s_or_b32 s82, s84, s80
v_mov_b32 v53, s82
s_lshl_b32 s84, s5, 4
v_mov_b32 v52, s84
s_mov_b32 s85, 0x3e000
s_mov_b64 exec, 1
buffer_store_dword v53, v52, s[40:43], s85 offen
s_mov_b64 exec, -1
s_mov_b32 m0, s83
s_add_u32 m0, s89, 8192
s_nop 0
buffer_load_dwordx4 v32, s[32:35], s62 offen offset:0 nt lds
s_waitcnt vmcnt(7)
buffer_load_dwordx4 v33, s[32:35], s62 offen offset:1024 nt lds
s_waitcnt vmcnt(7)
v_and_b32 v47, 15, v1
v_lshrrev_b32 v48, 4, v1
v_and_b32 v51, 3, v1
s_lshl_b32 s84, s6, 10
v_lshlrev_b32 v49, 4, v51
v_lshl_add_u32 v49, v48, 6, v49
v_add_u32 v4, s84, v49
v_xor_b32 v49, v48, v51
v_lshlrev_b32 v49, 4, v49
v_lshl_add_u32 v49, v51, 9, v49
v_lshrrev_b32 v50, 2, v47
v_lshl_add_u32 v49, v50, 6, v49
s_add_u32 s84, s3, 1
s_lshl_b32 s84, s84, 13
v_add_u32 v5, s84, v49
s_lshr_b32 s84, s3, 1
s_lshl_b32 s85, s84, 9
s_and_b32 s86, s3, 1
s_lshl_b32 s86, s86, 8
s_add_u32 s85, s85, s86
v_lshrrev_b32 v49, 2, v1
v_and_b32 v49, 3, v49
v_xor_b32 v49, s84, v49
v_lshlrev_b32 v49, 4, v49
v_lshrrev_b32 v50, 4, v1
v_lshl_add_u32 v49, v50, 6, v49
v_and_b32 v50, 3, v1
v_lshl_add_u32 v49, v50, 2, v49
s_add_u32 s85, s85, 8192
v_add_u32 v6, s85, v49
s_mul_i32 s85, s5, 2176
s_lshl_b32 s86, s3, 8
s_add_u32 s85, s85, s86
v_lshl_add_u32 v8, v1, 2, s85
s_lshl_b32 s85, s3, 5
s_add_u32 s85, s85, 156672
v_lshl_add_u32 v29, v51, 3, s85
s_lshl_b32 s84, s84, 3
s_add_u32 s84, s84, 156672
v_mov_b32 v30, s84
v_lshlrev_b32 v49, 4, v47
v_lshl_add_u32 v49, v48, 7, v49
s_lshl_b32 s84, s59, 11
v_add_u32 v2, s84, v49
s_lshl_b32 s84, s59, 10
v_add_u32 v3, s84, v49
s_lshl_b32 s84, s59, 13
s_add_u32 s84, s84, 43008
v_lshl_add_u32 v9, v1, 4, s84
s_and_b32 s97, s5, 7
s_lshr_b32 s84, s5, 3
s_mov_b32 s96, s84
s_cmp_eq_u32 s84, 1
s_cselect_b32 s96, 0, s96
s_cmp_eq_u32 s84, 0
s_cselect_b32 s96, 1, s96
s_cmp_eq_u32 s5, 23
s_cselect_b32 s96, 0, s96
v_lshrrev_b32 v49, 2, v47
v_lshl_add_u32 v50, v48, 3, v49
v_and_b32 v51, 3, v1
v_lshlrev_b32 v51, 3, v51
v_and_b32 v52, 1, v48
s_cmp_eq_u32 s96, 2
s_cbranch_scc1 L_rg_10
v_lshrrev_b32 v49, 1, v49
v_lshl_add_u32 v49, v52, 1, v49
v_lshl_add_u32 v51, v49, 5, v51
v_lshl_add_u32 v51, v50, 7, v51
s_cmp_eq_u32 s96, 1
s_cselect_b32 s84, 14, 13
s_lshl_b32 s84, s59, s84
s_branch L_re_11
L_rg_10:
v_lshl_add_u32 v51, v52, 5, v51
v_lshl_add_u32 v51, v50, 6, v51
s_lshl_b32 s84, s59, 13
L_re_11:
s_add_u32 s84, s84, 73728
v_add_u32 v10, s84, v51
v_lshrrev_b32 v49, 3, v1
v_and_b32 v50, 7, v1
v_lshrrev_b32 v51, 2, v49
v_lshlrev_b32 v51, 8, v51
v_and_b32 v52, 3, v49
v_lshl_add_u32 v51, v52, 2, v51
v_add_u32 v51, 43008, v51
s_lshl_b32 s84, s3, 10
v_lshl_add_u32 v12, v50, 5, v51
v_add_u32 v12, s84, v12
v_add_u32 v23, 4224, v51
v_lshl_add_u32 v24, v49, 4, v51
v_add_u32 v24, 4096, v24
v_lshlrev_b32 v52, 5, v50
s_add_u32 s84, s84, 43520
v_add_u32 v25, s84, v52
v_lshlrev_b32 v14, 3, v1
s_lshl_b32 s84, s97, 2
s_add_u32 s84, s84, s3
s_lshl_b32 s85, s84, 2
v_mov_b32 v28, s85
s_lshl_b32 s84, s84, 13
s_lshl_b32 s85, s4, 10
s_add_u32 s84, s84, s85
v_lshl_add_u32 v13, v1, 4, s84
s_lshl_b32 s84, s98, 13
v_lshl_add_u32 v26, v1, 4, s84
v_and_b32 v52, 3, v50
v_lshlrev_b32 v52, 2, v52
v_lshl_add_u32 v52, v49, 4, v52
v_lshrrev_b32 v53, 2, v50
v_lshl_add_u32 v15, v53, 7, v52
s_lshl_b32 s84, s98, 8
v_add_u32 v15, s84, v15
v_lshlrev_b32 v52, 2, v50
v_lshl_add_u32 v52, v49, 10, v52
s_lshl_b32 s84, s98, 5
v_add_u32 v7, s84, v52
s_and_b32 s84, s5, 7
s_lshr_b32 s85, s84, 1
s_lshl_b32 s85, s85, 8
s_and_b32 s84, s5, 1
s_lshl_b32 s84, s84, 7
s_add_u32 s85, s85, s84
s_lshr_b32 s84, s5, 3
s_lshl_b32 s84, s84, 4
s_add_u32 s85, s85, s84
v_and_b32 v52, 3, v50
v_lshlrev_b32 v52, 2, v52
v_lshl_add_u32 v52, v53, 6, v52
v_lshl_add_u32 v52, v49, 10, v52
v_add_u32 v54, s85, v52
s_lshl_b32 s84, s97, 1
s_add_u32 s84, s84, s3
s_sub_u32 s84, s84, s98
s_lshl_b32 s84, s84, 8
v_add_u32 v27, s84, v15
s_mul_i32 s84, s6, 8704
s_lshl_b32 s85, s7, 9
s_add_u32 s85, s85, s84
v_add_u32 v18, s85, v14
v_add_u32 v19, 4352, v18
s_lshl_b32 s85, s7, 3
s_add_u32 s85, s85, s84
s_add_u32 s85, s85, 2048
v_mov_b32 v20, s85
v_add_u32 v21, 4352, v20
s_lshl_b32 s84, s6, 4
s_lshl_b32 s85, s7, 11
s_add_u32 s84, s84, s85
v_and_b32 v52, 3, v1
v_lshlrev_b32 v52, 2, v52
v_lshrrev_b32 v53, 2, v1
v_lshl_add_u32 v52, v53, 7, v52
v_add_u32 v22, s84, v52
buffer_load_dwordx4 v34, s[32:35], s62 offen offset:2048 nt lds
s_waitcnt vmcnt(7)
ds_read_b128 v[64:67], v38 offset:0
ds_read_b128 v[68:71], v39 offset:0
ds_read_b128 v[72:75], v40 offset:0
ds_read_b128 v[76:79], v41 offset:0
buffer_load_dwordx4 v35, s[32:35], s62 offen offset:3072 nt lds
s_waitcnt vmcnt(7)
s_add_u32 m0, s89, 12288
s_nop 0
buffer_load_dwordx4 v32, s[32:35], s63 offen offset:0 nt lds
s_waitcnt vmcnt(7)
buffer_load_dwordx4 v33, s[32:35], s63 offen offset:1024 nt lds
s_waitcnt vmcnt(7)
buffer_load_dwordx4 v34, s[32:35], s63 offen offset:2048 nt lds
s_waitcnt vmcnt(7)
ds_read_b128 v[80:83], v38 offset:4096
ds_read_b128 v[84:87], v39 offset:4096
ds_read_b128 v[88:91], v40 offset:4096
ds_read_b128 v[92:95], v41 offset:4096
buffer_load_dwordx4 v35, s[32:35], s63 offen offset:3072 nt lds
s_waitcnt vmcnt(7)
s_waitcnt lgkmcnt(0)
s_add_u32 m0, s89, 0
s_nop 0
buffer_load_dwordx4 v36, s[36:39], s60 offen offset:0 nt lds
s_waitcnt vmcnt(7)
s_mov_b32 s83, m0
v_lshrrev_b32 v248, 1, v1
v_lshlrev_b32 v248, 9, v248
v_and_b32 v249, 1, v1
v_lshl_add_u32 v248, v249, 5, v248
s_lshl_b32 s84, s6, 6
s_add_u32 s84, s84, 0x38000
buffer_load_dwordx4 v[240:243], v248, s[40:43], s84 offen sc1
buffer_load_dwordx4 v[244:247], v248, s[40:43], s84 offen offset:16 sc1
s_mov_b32 m0, s83
s_nop 0
buffer_load_dwordx4 v37, s[36:39], s60 offen offset:1024 nt lds
s_waitcnt vmcnt(7)
buffer_load_dwordx4 v36, s[36:39], s60 offen offset:2048 nt lds
s_waitcnt vmcnt(7)
ds_read_b128 v[96:99], v38 offset:8192
ds_read_b128 v[100:103], v39 offset:8192
ds_read_b128 v[104:107], v40 offset:8192
ds_read_b128 v[108:111], v41 offset:8192
buffer_load_dwordx4 v37, s[36:39], s60 offen offset:3072 nt lds
s_waitcnt vmcnt(7)
s_waitcnt lgkmcnt(0)
s_add_u32 m0, s89, 4096
s_nop 0
buffer_load_dwordx4 v36, s[36:39], s61 offen offset:0 nt lds
s_waitcnt vmcnt(7)
buffer_load_dwordx4 v37, s[36:39], s61 offen offset:1024 nt lds
s_waitcnt vmcnt(7)
buffer_load_dwordx4 v36, s[36:39], s61 offen offset:2048 nt lds
s_waitcnt vmcnt(7)
ds_read_b128 v[112:115], v38 offset:12288
ds_read_b128 v[116:119], v39 offset:12288
ds_read_b128 v[120:123], v40 offset:12288
ds_read_b128 v[124:127], v41 offset:12288
buffer_load_dwordx4 v37, s[36:39], s61 offen offset:3072 nt lds
s_waitcnt vmcnt(7)
s_waitcnt lgkmcnt(0)
s_mov_b32 s83, m0
v_lshlrev_b32 v60, 4, v1
s_mov_b32 s85, 0x3e000
s_mov_b32 exec_lo, -1
s_mov_b32 exec_hi, 0
buffer_load_dword v61, v60, s[40:43], s85 offen sc1
s_mov_b64 exec, -1
s_mov_b32 m0, s83
s_add_u32 m0, s89, 8192
s_nop 0
buffer_load_dwordx4 v36, s[36:39], s62 offen offset:0 nt lds
s_waitcnt vmcnt(7)
s_mov_b32 s83, m0
s_cmp_eq_u32 s72, 1
s_cbranch_scc1 L_gt_e_13
v_xor_b32 v50, s80, v241
v_xor_b32 v51, s80, v243
v_xor_b32 v52, s80, v245
v_xor_b32 v53, s80, v247
v_or3_b32 v50, v50, v51, v52
v_or_b32 v50, v50, v53
v_cmp_ne_u32 vcc, 0, v50
s_cbranch_vccnz L_gt_f_12
v_mov_b32 v241, v242
v_mov_b32 v242, v244
v_mov_b32 v243, v246
v_lshrrev_b32 v248, 2, v1
v_and_b32 v248, 3, v248
v_lshlrev_b32 v248, 8, v248
v_and_b32 v249, 3, v1
v_lshl_add_u32 v248, v249, 6, v248
v_lshrrev_b32 v249, 4, v1
v_lshl_add_u32 v248, v249, 4, v248
v_add_u32 v248, 155648, v248
ds_write_b128 v248, v[240:243]
s_waitcnt lgkmcnt(0)
v_mov_b32 v248, 156928
v_mov_b32 v249, 1
ds_write_b32 v248, v249 offset:16
s_mov_b32 s72, 1
s_branch L_gt_e_13
L_gt_f_12:
v_lshrrev_b32 v248, 1, v1
v_lshlrev_b32 v248, 9, v248
v_and_b32 v249, 1, v1
v_lshl_add_u32 v248, v249, 5, v248
s_lshl_b32 s84, s6, 6
s_add_u32 s84, s84, 0x38000
buffer_load_dwordx4 v[240:243], v248, s[40:43], s84 offen sc1
buffer_load_dwordx4 v[244:247], v248, s[40:43], s84 offen offset:16 sc1
L_gt_e_13:
s_mov_b32 m0, s83
s_nop 0
buffer_load_dwordx4 v37, s[36:39], s62 offen offset:1024 nt lds
s_waitcnt vmcnt(7)
buffer_load_dwordx4 v36, s[36:39], s62 offen offset:2048 nt lds
s_waitcnt vmcnt(7)
ds_read_b64_tr_b16 v[128:129], v42 offset:0
v_xor_b32 v49, 32, v42
ds_read_b64_tr_b16 v[132:133], v49 offset:0
v_xor_b32 v48, 64, v42
ds_read_b64_tr_b16 v[136:137], v48 offset:0
v_xor_b32 v49, 96, v42
ds_read_b64_tr_b16 v[140:141], v49 offset:0
v_xor_b32 v48, 128, v42
ds_read_b64_tr_b16 v[144:145], v48 offset:0
v_xor_b32 v49, 160, v42
ds_read_b64_tr_b16 v[148:149], v49 offset:0
v_xor_b32 v48, 192, v42
ds_read_b64_tr_b16 v[152:153], v48 offset:0
v_xor_b32 v49, 224, v42
ds_read_b64_tr_b16 v[156:157], v49 offset:0
buffer_load_dwordx4 v37, s[36:39], s62 offen offset:3072 nt lds
s_waitcnt vmcnt(7)
s_waitcnt lgkmcnt(0)
s_add_u32 m0, s89, 12288
s_nop 0
buffer_load_dwordx4 v36, s[36:39], s63 offen offset:0 nt lds
s_waitcnt vmcnt(7)
buffer_load_dwordx4 v37, s[36:39], s63 offen offset:1024 nt lds
s_waitcnt vmcnt(7)
buffer_load_dwordx4 v36, s[36:39], s63 offen offset:2048 nt lds
s_waitcnt vmcnt(7)
ds_read_b64_tr_b16 v[130:131], v42 offset:4096
v_xor_b32 v49, 32, v42
ds_read_b64_tr_b16 v[134:135], v49 offset:4096
v_xor_b32 v48, 64, v42
ds_read_b64_tr_b16 v[138:139], v48 offset:4096
v_xor_b32 v49, 96, v42
ds_read_b64_tr_b16 v[142:143], v49 offset:4096
v_xor_b32 v48, 128, v42
ds_read_b64_tr_b16 v[146:147], v48 offset:4096
v_xor_b32 v49, 160, v42
ds_read_b64_tr_b16 v[150:151], v49 offset:4096
v_xor_b32 v48, 192, v42
ds_read_b64_tr_b16 v[154:155], v48 offset:4096
v_xor_b32 v49, 224, v42
ds_read_b64_tr_b16 v[158:159], v49 offset:4096
buffer_load_dwordx4 v37, s[36:39], s63 offen offset:3072 nt lds
s_waitcnt vmcnt(4)
ds_read_b64_tr_b16 v[160:161], v42 offset:8192
v_xor_b32 v49, 32, v42
ds_read_b64_tr_b16 v[164:165], v49 offset:8192
v_xor_b32 v48, 64, v42
ds_read_b64_tr_b16 v[168:169], v48 offset:8192
v_xor_b32 v49, 96, v42
ds_read_b64_tr_b16 v[172:173], v49 offset:8192
v_xor_b32 v48, 128, v42
ds_read_b64_tr_b16 v[176:177], v48 offset:8192
v_xor_b32 v49, 160, v42
ds_read_b64_tr_b16 v[180:181], v49 offset:8192
v_xor_b32 v48, 192, v42
ds_read_b64_tr_b16 v[184:185], v48 offset:8192
v_xor_b32 v49, 224, v42
ds_read_b64_tr_b16 v[188:189], v49 offset:8192
s_waitcnt vmcnt(0)
ds_read_b64_tr_b16 v[162:163], v42 offset:12288
v_xor_b32 v49, 32, v42
ds_read_b64_tr_b16 v[166:167], v49 offset:12288
v_xor_b32 v48, 64, v42
ds_read_b64_tr_b16 v[170:171], v48 offset:12288
v_xor_b32 v49, 96, v42
ds_read_b64_tr_b16 v[174:175], v49 offset:12288
v_xor_b32 v48, 128, v42
ds_read_b64_tr_b16 v[178:179], v48 offset:12288
v_xor_b32 v49, 160, v42
ds_read_b64_tr_b16 v[182:183], v49 offset:12288
v_xor_b32 v48, 192, v42
ds_read_b64_tr_b16 v[186:187], v48 offset:12288
v_xor_b32 v49, 224, v42
ds_read_b64_tr_b16 v[190:191], v49 offset:12288
s_cmp_eq_u32 s72, 1
s_cbranch_scc1 L_gq_e_16
L_gq_14:
s_waitcnt vmcnt(0)
v_xor_b32 v50, s80, v241
v_xor_b32 v51, s80, v243
v_xor_b32 v52, s80, v245
v_xor_b32 v53, s80, v247
v_or3_b32 v50, v50, v51, v52
v_or_b32 v50, v50, v53
v_cmp_ne_u32 vcc, 0, v50
s_cbranch_vccnz L_gq_f_15
v_mov_b32 v241, v242
v_mov_b32 v242, v244
v_mov_b32 v243, v246
v_lshrrev_b32 v248, 2, v1
v_and_b32 v248, 3, v248
v_lshlrev_b32 v248, 8, v248
v_and_b32 v249, 3, v1
v_lshl_add_u32 v248, v249, 6, v248
v_lshrrev_b32 v249, 4, v1
v_lshl_add_u32 v248, v249, 4, v248
v_add_u32 v248, 155648, v248
ds_write_b128 v248, v[240:243]
s_waitcnt lgkmcnt(0)
v_mov_b32 v248, 156928
v_mov_b32 v249, 1
ds_write_b32 v248, v249 offset:16
s_mov_b32 s72, 1
s_branch L_gq_e_16
L_gq_f_15:
v_lshrrev_b32 v248, 1, v1
v_lshlrev_b32 v248, 9, v248
v_and_b32 v249, 1, v1
v_lshl_add_u32 v248, v249, 5, v248
s_lshl_b32 s84, s6, 6
s_add_u32 s84, s84, 0x38000
buffer_load_dwordx4 v[240:243], v248, s[40:43], s84 offen sc1
buffer_load_dwordx4 v[244:247], v248, s[40:43], s84 offen offset:16 sc1
s_sub_u32 s58, s58, 1
s_cbranch_scc1 L_END
s_branch L_gq_14
L_gq_e_16:
s_waitcnt vmcnt(0)
s_mov_b32 s86, 3000
L_ARR:
s_mov_b32 exec_lo, -1
s_mov_b32 exec_hi, 0
v_xor_b32 v50, s80, v61
v_cmp_lt_u32 vcc, 15, v50
s_mov_b64 exec, -1
s_cbranch_vccz L_ARR_OK
s_sub_u32 s86, s86, 1
s_cbranch_scc1 L_ARR_SLOW
s_sleep 8
s_mov_b32 s85, 0x3e000
s_mov_b32 exec_lo, -1
s_mov_b32 exec_hi, 0
buffer_load_dword v61, v60, s[40:43], s85 offen sc1
s_mov_b64 exec, -1
s_waitcnt vmcnt(0)
s_branch L_ARR
L_ARR_OK:
s_mov_b32 exec_lo, -1
s_mov_b32 exec_hi, 0
v_cmp_ne_u32 vcc, s82, v61
s_mov_b64 exec, -1
s_mov_b32 s56, 1
s_cbranch_vccz L_MODE_OK
L_ARR_SLOW:
s_mov_b32 s56, 2
buffer_wbl2 sc1
s_waitcnt vmcnt(0)
v_mov_b32 v53, s80
s_lshl_b32 s84, s5, 4
v_mov_b32 v52, s84
s_mov_b32 s85, 0x3e400
s_mov_b64 exec, 1
buffer_store_dword v53, v52, s[40:43], s85 offen sc1
s_mov_b64 exec, -1
L_ARR2:
s_mov_b32 s85, 0x3e400
s_mov_b32 exec_lo, -1
s_mov_b32 exec_hi, 0
buffer_load_dword v61, v60, s[40:43], s85 offen sc1
s_mov_b64 exec, -1
s_sub_u32 s58, s58, 1
s_cbranch_scc1 L_END
s_waitcnt vmcnt(0)
s_mov_b32 exec_lo, -1
s_mov_b32 exec_hi, 0
v_cmp_ne_u32 vcc, s80, v61
s_mov_b64 exec, -1
s_cbranch_vccnz L_ARR2
L_MODE_OK:
v_mov_b32 v50, 156928
v_mov_b32 v51, s56
v_mov_b32 v52, s80
ds_write_b32 v50, v51
ds_write_b32 v50, v52 offset:20
v_lshlrev_b32 v50, 4, v1
s_lshl_b32 s84, s5, 8
s_add_u32 s84, s84, 0x2000
s_lshl_b32 s85, s5, 9
s_add_u32 s85, s85, 0x9f00
v_mov_b32 v51, s85
v_mov_b32 v52, s84
v_cmp_gt_u32 vcc, 16, v1
s_nop 1
v_cndmask_b32 v51, v51, v52, vcc
v_add_u32 v50, v50, v51
s_mov_b32 exec_lo, -1
s_mov_b32 exec_hi, 0xffff
buffer_load_dwordx4 v[60:63], v50, s[40:43], 0 offen sc1
s_mov_b64 exec, -1
s_mul_i32 s84, s5, 2176
s_add_u32 s84, s84, 0x10000
v_lshlrev_b32 v50, 4, v1
buffer_load_dwordx4 v[60:63], v50, s[40:43], s84 offen sc1
buffer_load_dwordx4 v[60:63], v50, s[40:43], s84 offen offset:1024 sc1
s_mov_b64 exec, 0xff
buffer_load_dwordx4 v[60:63], v50, s[40:43], s84 offen offset:2048 sc1
s_mov_b64 exec, -1
s_branch L_STRM_DONE
L_NOTW0:
s_waitcnt vmcnt(3)
s_add_u32 m0, s89, 4096
s_nop 0
buffer_load_dwordx4 v32, s[32:35], s61 offen offset:0 nt lds
s_waitcnt vmcnt(3)
buffer_load_dwordx4 v33, s[32:35], s61 offen offset:1024 nt lds
s_waitcnt vmcnt(3)
buffer_load_dwordx4 v34, s[32:35], s61 offen offset:2048 nt lds
s_waitcnt vmcnt(3)
ds_read_b128 v[64:67], v38 offset:0
ds_read_b128 v[68:71], v39 offset:0
ds_read_b128 v[72:75], v40 offset:0
ds_read_b128 v[76:79], v41 offset:0
buffer_load_dwordx4 v35, s[32:35], s61 offen offset:3072 nt lds
s_waitcnt vmcnt(3)
s_waitcnt lgkmcnt(0)
v_mov_b32 v48, 156928
v_mov_b32 v49, 1
s_mov_b64 exec, 1
ds_add_u32 v48, v49 offset:12
s_mov_b64 exec, -1
s_add_u32 m0, s89, 0
s_nop 0
buffer_load_dwordx4 v32, s[32:35], s62 offen offset:0 nt lds
s_waitcnt vmcnt(3)
buffer_load_dwordx4 v33, s[32:35], s62 offen offset:1024 nt lds
s_waitcnt vmcnt(3)
v_and_b32 v47, 15, v1
v_lshrrev_b32 v48, 4, v1
v_and_b32 v51, 3, v1
s_lshl_b32 s84, s6, 10
v_lshlrev_b32 v49, 4, v51
v_lshl_add_u32 v49, v48, 6, v49
v_add_u32 v4, s84, v49
v_xor_b32 v49, v48, v51
v_lshlrev_b32 v49, 4, v49
v_lshl_add_u32 v49, v51, 9, v49
v_lshrrev_b32 v50, 2, v47
v_lshl_add_u32 v49, v50, 6, v49
s_add_u32 s84, s3, 1
s_lshl_b32 s84, s84, 13
v_add_u32 v5, s84, v49
s_lshr_b32 s84, s3, 1
s_lshl_b32 s85, s84, 9
s_and_b32 s86, s3, 1
s_lshl_b32 s86, s86, 8
s_add_u32 s85, s85, s86
v_lshrrev_b32 v49, 2, v1
v_and_b32 v49, 3, v49
v_xor_b32 v49, s84, v49
v_lshlrev_b32 v49, 4, v49
v_lshrrev_b32 v50, 4, v1
v_lshl_add_u32 v49, v50, 6, v49
v_and_b32 v50, 3, v1
v_lshl_add_u32 v49, v50, 2, v49
s_add_u32 s85, s85, 8192
v_add_u32 v6, s85, v49
s_mul_i32 s85, s5, 2176
s_lshl_b32 s86, s3, 8
s_add_u32 s85, s85, s86
v_lshl_add_u32 v8, v1, 2, s85
s_lshl_b32 s85, s3, 5
s_add_u32 s85, s85, 156672
v_lshl_add_u32 v29, v51, 3, s85
s_lshl_b32 s84, s84, 3
s_add_u32 s84, s84, 156672
v_mov_b32 v30, s84
v_lshlrev_b32 v49, 4, v47
v_lshl_add_u32 v49, v48, 7, v49
s_lshl_b32 s84, s59, 11
v_add_u32 v2, s84, v49
s_lshl_b32 s84, s59, 10
v_add_u32 v3, s84, v49
s_lshl_b32 s84, s59, 13
s_add_u32 s84, s84, 43008
v_lshl_add_u32 v9, v1, 4, s84
s_and_b32 s97, s5, 7
s_lshr_b32 s84, s5, 3
s_mov_b32 s96, s84
s_cmp_eq_u32 s84, 1
s_cselect_b32 s96, 0, s96
s_cmp_eq_u32 s84, 0
s_cselect_b32 s96, 1, s96
s_cmp_eq_u32 s5, 23
s_cselect_b32 s96, 0, s96
v_lshrrev_b32 v49, 2, v47
v_lshl_add_u32 v50, v48, 3, v49
v_and_b32 v51, 3, v1
v_lshlrev_b32 v51, 3, v51
v_and_b32 v52, 1, v48
s_cmp_eq_u32 s96, 2
s_cbranch_scc1 L_rg_17
v_lshrrev_b32 v49, 1, v49
v_lshl_add_u32 v49, v52, 1, v49
v_lshl_add_u32 v51, v49, 5, v51
v_lshl_add_u32 v51, v50, 7, v51
s_cmp_eq_u32 s96, 1
s_cselect_b32 s84, 14, 13
s_lshl_b32 s84, s59, s84
s_branch L_re_18
L_rg_17:
v_lshl_add_u32 v51, v52, 5, v51
v_lshl_add_u32 v51, v50, 6, v51
s_lshl_b32 s84, s59, 13
L_re_18:
s_add_u32 s84, s84, 73728
v_add_u32 v10, s84, v51
v_lshrrev_b32 v49, 3, v1
v_and_b32 v50, 7, v1
v_lshrrev_b32 v51, 2, v49
v_lshlrev_b32 v51, 8, v51
v_and_b32 v52, 3, v49
v_lshl_add_u32 v51, v52, 2, v51
v_add_u32 v51, 43008, v51
s_lshl_b32 s84, s3, 10
v_lshl_add_u32 v12, v50, 5, v51
v_add_u32 v12, s84, v12
v_add_u32 v23, 4224, v51
v_lshl_add_u32 v24, v49, 4, v51
v_add_u32 v24, 4096, v24
v_lshlrev_b32 v52, 5, v50
s_add_u32 s84, s84, 43520
v_add_u32 v25, s84, v52
v_lshlrev_b32 v14, 3, v1
s_lshl_b32 s84, s97, 2
s_add_u32 s84, s84, s3
s_lshl_b32 s85, s84, 2
v_mov_b32 v28, s85
s_lshl_b32 s84, s84, 13
s_lshl_b32 s85, s4, 10
s_add_u32 s84, s84, s85
v_lshl_add_u32 v13, v1, 4, s84
s_lshl_b32 s84, s98, 13
v_lshl_add_u32 v26, v1, 4, s84
v_and_b32 v52, 3, v50
v_lshlrev_b32 v52, 2, v52
v_lshl_add_u32 v52, v49, 4, v52
v_lshrrev_b32 v53, 2, v50
v_lshl_add_u32 v15, v53, 7, v52
s_lshl_b32 s84, s98, 8
v_add_u32 v15, s84, v15
v_lshlrev_b32 v52, 2, v50
v_lshl_add_u32 v52, v49, 10, v52
s_lshl_b32 s84, s98, 5
v_add_u32 v7, s84, v52
s_and_b32 s84, s5, 7
s_lshr_b32 s85, s84, 1
s_lshl_b32 s85, s85, 8
s_and_b32 s84, s5, 1
s_lshl_b32 s84, s84, 7
s_add_u32 s85, s85, s84
s_lshr_b32 s84, s5, 3
s_lshl_b32 s84, s84, 4
s_add_u32 s85, s85, s84
v_and_b32 v52, 3, v50
v_lshlrev_b32 v52, 2, v52
v_lshl_add_u32 v52, v53, 6, v52
v_lshl_add_u32 v52, v49, 10, v52
v_add_u32 v54, s85, v52
s_lshl_b32 s84, s97, 1
s_add_u32 s84, s84, s3
s_sub_u32 s84, s84, s98
s_lshl_b32 s84, s84, 8
v_add_u32 v27, s84, v15
s_mul_i32 s84, s6, 8704
s_lshl_b32 s85, s7, 9
s_add_u32 s85, s85, s84
v_add_u32 v18, s85, v14
v_add_u32 v19, 4352, v18
s_lshl_b32 s85, s7, 3
s_add_u32 s85, s85, s84
s_add_u32 s85, s85, 2048
v_mov_b32 v20, s85
v_add_u32 v21, 4352, v20
s_lshl_b32 s84, s6, 4
s_lshl_b32 s85, s7, 11
s_add_u32 s84, s84, s85
v_and_b32 v52, 3, v1
v_lshlrev_b32 v52, 2, v52
v_lshrrev_b32 v53, 2, v1
v_lshl_add_u32 v52, v53, 7, v52
v_add_u32 v22, s84, v52
buffer_load_dwordx4 v34, s[32:35], s62 offen offset:2048 nt lds
s_waitcnt vmcnt(3)
ds_read_b128 v[80:83], v38 offset:4096
ds_read_b128 v[84:87], v39 offset:4096
ds_read_b128 v[88:91], v40 offset:4096
ds_read_b128 v[92:95], v41 offset:4096
buffer_load_dwordx4 v35, s[32:35], s62 offen offset:3072 nt lds
s_waitcnt vmcnt(3)
s_waitcnt lgkmcnt(0)
s_add_u32 m0, s89, 4096
s_nop 0
buffer_load_dwordx4 v32, s[32:35], s63 offen offset:0 nt lds
s_waitcnt vmcnt(3)
buffer_load_dwordx4 v33, s[32:35], s63 offen offset:1024 nt lds
s_waitcnt vmcnt(3)
buffer_load_dwordx4 v34, s[32:35], s63 offen offset:2048 nt lds
s_waitcnt vmcnt(3)
ds_read_b128 v[96:99], v38 offset:0
ds_read_b128 v[100:103], v39 offset:0
ds_read_b128 v[104:107], v40 offset:0
ds_read_b128 v[108:111], v41 offset:0
buffer_load_dwordx4 v35, s[32:35], s63 offen offset:3072 nt lds
s_waitcnt vmcnt(3)
s_waitcnt lgkmcnt(0)
s_add_u32 m0, s89, 0
s_nop 0
buffer_load_dwordx4 v36, s[36:39], s60 offen offset:0 nt lds
s_waitcnt vmcnt(3)
buffer_load_dwordx4 v37, s[36:39], s60 offen offset:1024 nt lds
s_waitcnt vmcnt(3)
buffer_load_dwordx4 v36, s[36:39], s60 offen offset:2048 nt lds
s_waitcnt vmcnt(3)
ds_read_b128 v[112:115], v38 offset:4096
ds_read_b128 v[116:119], v39 offset:4096
ds_read_b128 v[120:123], v40 offset:4096
ds_read_b128 v[124:127], v41 offset:4096
buffer_load_dwordx4 v37, s[36:39], s60 offen offset:3072 nt lds
s_waitcnt vmcnt(3)
s_waitcnt lgkmcnt(0)
s_add_u32 m0, s89, 4096
s_nop 0
buffer_load_dwordx4 v36, s[36:39], s61 offen offset:0 nt lds
s_waitcnt vmcnt(3)
buffer_load_dwordx4 v37, s[36:39], s61 offen offset:1024 nt lds
s_waitcnt vmcnt(3)
buffer_load_dwordx4 v36, s[36:39], s61 offen offset:2048 nt lds
s_waitcnt vmcnt(3)
ds_read_b64_tr_b16 v[128:129], v42 offset:0
v_xor_b32 v49, 32, v42
ds_read_b64_tr_b16 v[132:133], v49 offset:0
v_xor_b32 v48, 64, v42
ds_read_b64_tr_b16 v[136:137], v48 offset:0
v_xor_b32 v49, 96, v42
ds_read_b64_tr_b16 v[140:141], v49 offset:0
v_xor_b32 v48, 128, v42
ds_read_b64_tr_b16 v[144:145], v48 offset:0
v_xor_b32 v49, 160, v42
ds_read_b64_tr_b16 v[148:149], v49 offset:0
v_xor_b32 v48, 192, v42
ds_read_b64_tr_b16 v[152:153], v48 offset:0
v_xor_b32 v49, 224, v42
ds_read_b64_tr_b16 v[156:157], v49 offset:0
buffer_load_dwordx4 v37, s[36:39], s61 offen offset:3072 nt lds
s_waitcnt vmcnt(3)
s_waitcnt lgkmcnt(0)
s_add_u32 m0, s89, 0
s_nop 0
buffer_load_dwordx4 v36, s[36:39], s62 offen offset:0 nt lds
s_waitcnt vmcnt(3)
buffer_load_dwordx4 v37, s[36:39], s62 offen offset:1024 nt lds
s_waitcnt vmcnt(3)
buffer_load_dwordx4 v36, s[36:39], s62 offen offset:2048 nt lds
s_waitcnt vmcnt(3)
ds_read_b64_tr_b16 v[130:131], v42 offset:4096
v_xor_b32 v49, 32, v42
ds_read_b64_tr_b16 v[134:135], v49 offset:4096
v_xor_b32 v48, 64, v42
ds_read_b64_tr_b16 v[138:139], v48 offset:4096
v_xor_b32 v49, 96, v42
ds_read_b64_tr_b16 v[142:143], v49 offset:4096
v_xor_b32 v48, 128, v42
ds_read_b64_tr_b16 v[146:147], v48 offset:4096
v_xor_b32 v49, 160, v42
ds_read_b64_tr_b16 v[150:151], v49 offset:4096
v_xor_b32 v48, 192, v42
ds_read_b64_tr_b16 v[154:155], v48 offset:4096
v_xor_b32 v49, 224, v42
ds_read_b64_tr_b16 v[158:159], v49 offset:4096
buffer_load_dwordx4 v37, s[36:39], s62 offen offset:3072 nt lds
s_waitcnt vmcnt(3)
s_waitcnt lgkmcnt(0)
s_add_u32 m0, s89, 4096
s_nop 0
buffer_load_dwordx4 v36, s[36:39], s63 offen offset:0 nt lds
s_waitcnt vmcnt(3)
buffer_load_dwordx4 v37, s[36:39], s63 offen offset:1024 nt lds
s_waitcnt vmcnt(3)
buffer_load_dwordx4 v36, s[36:39], s63 offen offset:2048 nt lds
s_waitcnt vmcnt(3)
ds_read_b64_tr_b16 v[160:161], v42 offset:0
v_xor_b32 v49, 32, v42
ds_read_b64_tr_b16 v[164:165], v49 offset:0
v_xor_b32 v48, 64, v42
ds_read_b64_tr_b16 v[168:169], v48 offset:0
v_xor_b32 v49, 96, v42
ds_read_b64_tr_b16 v[172:173], v49 offset:0
v_xor_b32 v48, 128, v42
ds_read_b64_tr_b16 v[176:177], v48 offset:0
v_xor_b32 v49, 160, v42
ds_read_b64_tr_b16 v[180:181], v49 offset:0
v_xor_b32 v48, 192, v42
ds_read_b64_tr_b16 v[184:185], v48 offset:0
v_xor_b32 v49, 224, v42
ds_read_b64_tr_b16 v[188:189], v49 offset:0
buffer_load_dwordx4 v37, s[36:39], s63 offen offset:3072 nt lds
L_STRM_DONE:
v_and_b32 v17, 0xffff0000, v16
v_lshlrev_b32 v16, 16, v16
v_mov_b32 v48, 156928
L_QRDY:
ds_read_b32 v49, v48 offset:16
s_sub_u32 s58, s58, 1
s_cbranch_scc1 L_END
s_waitcnt lgkmcnt(0)
v_cmp_ne_u32 vcc, 1, v49
s_cbranch_vccz L_spin_ok_19
s_sleep 1
s_branch L_QRDY
L_spin_ok_19:
v_and_b32 v51, 3, v1
v_lshlrev_b32 v51, 4, v51
v_lshrrev_b32 v52, 4, v1
v_lshl_add_u32 v51, v52, 6, v51
v_add_u32 v51, 155648, v51
ds_read_b128 v[192:195], v51 offset:0
ds_read_b128 v[196:199], v51 offset:256
ds_read_b128 v[200:203], v51 offset:512
ds_read_b128 v[204:207], v51 offset:768
s_waitcnt lgkmcnt(0)
s_mov_b32 s57, 0
s_branch L_ATT
L_LAYER:
s_cmp_lt_u32 s3, 4
s_cbranch_scc1 L_q_nc_20
L_poll_21:
s_mov_b64 exec, s[64:65]
buffer_load_dwordx4 v[192:195], v2, s[40:43], s73 offen offset:0 sc1
buffer_load_dwordx4 v[196:199], v2, s[40:43], s73 offen offset:512 sc1
buffer_load_dwordx4 v[200:203], v2, s[40:43], s73 offen offset:1024 sc1
buffer_load_dwordx4 v[204:207], v2, s[40:43], s73 offen offset:1536 sc1
s_mov_b64 exec, -1
s_sub_u32 s58, s58, 1
s_cbranch_scc1 L_END
s_waitcnt vmcnt(0)
v_max3_u32 v44, v192, v193, v194
v_max3_u32 v44, v44, v195, v196
v_max3_u32 v44, v44, v197, v198
v_max3_u32 v44, v44, v199, v200
v_max3_u32 v44, v44, v201, v202
v_max3_u32 v44, v44, v203, v204
v_max3_u32 v44, v44, v205, v206
v_max_u32 v44, v44, v207
v_cmp_eq_u32 vcc, -1, v44
s_cbranch_vccnz L_poll_21
s_waitcnt lgkmcnt(0)
v_mfma_f32_16x16x32_bf16 v[240:243], v[192:195], v[208:211], 0
v_mfma_f32_16x16x32_bf16 v[240:243], v[196:199], v[212:215], v[240:243]
v_mfma_f32_16x16x32_bf16 v[240:243], v[200:203], v[216:219], v[240:243]
v_mfma_f32_16x16x32_bf16 v[240:243], v[204:207], v[220:223], v[240:243]
v_mfma_f32_16x16x32_bf16 v[44:47], v[192:195], v[192:195], 0
v_mfma_f32_16x16x32_bf16 v[44:47], v[196:199], v[196:199], v[44:47]
v_mfma_f32_16x16x32_bf16 v[44:47], v[200:203], v[200:203], v[44:47]
v_mfma_f32_16x16x32_bf16 v[44:47], v[204:207], v[204:207], v[44:47]
s_nop 3
ds_write_b128 v9, v[240:243]
s_nop 2
ds_write_b128 v9, v[44:47] offset:4096
s_waitcnt lgkmcnt(0)
L_q_nc_20:
s_barrier
s_cmp_eq_u32 s3, 0
s_cbranch_scc0 L_q_nf_22
v_add_u32 v45, 16, v12
v_add_u32 v46, 16, v25
ds_read2st64_b32 v[208:209], v23 offset0:0 offset1:32
ds_read2st64_b32 v[210:211], v23 offset0:64 offset1:96
ds_read2st64_b32 v[212:213], v24 offset0:0 offset1:32
ds_read2st64_b32 v[214:215], v24 offset0:64 offset1:96
ds_read2st64_b32 v[192:193], v12 offset0:0 offset1:32
ds_read2st64_b32 v[194:195], v12 offset0:64 offset1:96
ds_read2st64_b32 v[196:197], v45 offset0:0 offset1:32
ds_read2st64_b32 v[198:199], v45 offset0:64 offset1:96
ds_read2st64_b32 v[200:201], v25 offset0:0 offset1:32
ds_read2st64_b32 v[202:203], v25 offset0:64 offset1:96
ds_read2st64_b32 v[204:205], v46 offset0:0 offset1:32
ds_read2st64_b32 v[206:207], v46 offset0:64 offset1:96
s_waitcnt lgkmcnt(8)
v_add_f32 v208, v208, v209
v_add_f32 v210, v210, v211
v_add_f32 v216, v208, v210
v_add_f32 v212, v212, v213
v_add_f32 v214, v214, v215
v_add_f32 v217, v212, v214
v_mul_f32 v216, s69, v216
v_mul_f32 v217, s69, v217
v_fma_f32 v217, -v216, v216, v217
v_max_f32 v217, 0, v217
v_add_f32 v217, s70, v217
v_rsq_f32 v217, v217
s_waitcnt lgkmcnt(0)
v_add_f32 v192, v192, v193
v_add_f32 v194, v194, v195
v_add_f32 v218, v192, v194
v_add_f32 v196, v196, v197
v_add_f32 v198, v198, v199
v_add_f32 v219, v196, v198
v_add_f32 v200, v200, v201
v_add_f32 v202, v202, v203
v_add_f32 v220, v200, v202
v_add_f32 v204, v204, v205
v_add_f32 v206, v206, v207
v_add_f32 v221, v204, v206
v_fma_f32 v218, -v216, v220, v218
v_fma_f32 v219, -v216, v221, v219
v_mul_f32 v218, v218, v217
v_mul_f32 v219, v219, v217
v_cvt_pk_bf16_f32 v45, v218, v219
v_min_u32 v45, v43, v45
s_cmp_eq_u32 s56, 1
s_cbranch_scc1 L_gsf_23
buffer_store_dword v45, v54, s[40:43], s72 offen sc1
s_branch L_gse_24
L_gsf_23:
buffer_store_dword v45, v54, s[40:43], s72 offen
L_gse_24:
L_q_nf_22:
v_mov_b32 v192, 0
v_mov_b32 v193, 0
v_mov_b32 v194, 0
v_mov_b32 v195, 0
v_mov_b32 v196, 0
v_mov_b32 v197, 0
v_mov_b32 v198, 0
v_mov_b32 v199, 0
v_mov_b32 v200, 0
v_mov_b32 v201, 0
v_mov_b32 v202, 0
v_mov_b32 v203, 0
v_mov_b32 v204, 0
v_mov_b32 v205, 0
v_mov_b32 v206, 0
v_mov_b32 v207, 0
s_barrier
L_poll_25:
s_mov_b32 exec_lo, 0x000f000f
s_mov_b32 exec_hi, 0x000f000f
buffer_load_dwordx4 v[192:195], v4, s[40:43], s72 offen offset:0 sc1
buffer_load_dwordx4 v[196:199], v4, s[40:43], s72 offen offset:256 sc1
buffer_load_dwordx4 v[200:203], v4, s[40:43], s72 offen offset:512 sc1
buffer_load_dwordx4 v[204:207], v4, s[40:43], s72 offen offset:768 sc1
s_mov_b64 exec, -1
s_sub_u32 s58, s58, 1
s_cbranch_scc1 L_END
s_waitcnt vmcnt(0)
v_max3_u32 v44, v192, v193, v194
v_max3_u32 v44, v44, v195, v196
v_max3_u32 v44, v44, v197, v198
v_max3_u32 v44, v44, v199, v200
v_max3_u32 v44, v44, v201, v202
v_max3_u32 v44, v44, v203, v204
v_max3_u32 v44, v44, v205, v206
v_max_u32 v44, v44, v207
v_cmp_eq_u32 vcc, -1, v44
s_cbranch_vccnz L_poll_25
L_ATT:
s_lshl_b32 s84, s57, 13
s_add_u32 s75, s84, 0xa000
s_lshl_b32 s85, s57, 14
s_add_u32 s79, s85, 0x4000
s_mul_i32 s85, s57, 69632
s_add_u32 s74, s85, 0x10000
s_lshl_b32 s85, s57, 12
s_add_u32 s76, s85, 0xe000
s_lshl_b32 s77, s57, 19
s_add_u32 s78, s77, 0x40000
s_lshl_b32 s81, s57, 8
s_add_u32 s81, s81, 0x3e800
s_cmp_lt_u32 s3, 4
s_cbranch_scc0 L_nres_26
s_cmp_eq_u32 s96, 1
s_cbranch_scc0 L_nres_26
s_cmp_eq_u32 s57, 1
s_cbranch_scc0 L_nres_26
s_mov_b32 s84, 0x6000
buffer_load_dword v16, v15, s[40:43], s84 offen sc1
L_nres_26:
s_cmp_lt_u32 s3, 4
s_cbranch_scc0 L_prio_27
s_setprio 1
L_prio_27:
v_mfma_f32_16x16x32_bf16 v[228:231], v[64:67], v[192:195], 0
v_mfma_f32_16x16x32_bf16 v[228:231], v[68:71], v[196:199], v[228:231]
v_mfma_f32_16x16x32_bf16 v[228:231], v[72:75], v[200:203], v[228:231]
v_mfma_f32_16x16x32_bf16 v[228:231], v[76:79], v[204:207], v[228:231]
v_mfma_f32_16x16x32_bf16 v[232:235], v[80:83], v[192:195], 0
v_mfma_f32_16x16x32_bf16 v[232:235], v[84:87], v[196:199], v[232:235]
v_mfma_f32_16x16x32_bf16 v[232:235], v[88:91], v[200:203], v[232:235]
v_mfma_f32_16x16x32_bf16 v[232:235], v[92:95], v[204:207], v[232:235]
v_mfma_f32_16x16x32_bf16 v[236:239], v[96:99], v[192:195], 0
v_mfma_f32_16x16x32_bf16 v[236:239], v[100:103], v[196:199], v[236:239]
v_mfma_f32_16x16x32_bf16 v[236:239], v[104:107], v[200:203], v[236:239]
v_mfma_f32_16x16x32_bf16 v[236:239], v[108:111], v[204:207], v[236:239]
v_max3_f32 v44, v228, v229, v230
v_mfma_f32_16x16x32_bf16 v[240:243], v[112:115], v[192:195], 0
v_mfma_f32_16x16x32_bf16 v[240:243], v[116:119], v[196:199], v[240:243]
v_mfma_f32_16x16x32_bf16 v[240:243], v[120:123], v[200:203], v[240:243]
v_mfma_f32_16x16x32_bf16 v[240:243], v[124:127], v[204:207], v[240:243]
v_max3_f32 v45, v232, v233, v234
v_max3_f32 v44, v44, v231, v235
s_nop 0
v_max3_f32 v45, v45, v236, v237
v_max3_f32 v44, v44, v238, v239
v_max_f32 v44, v44, v45
s_nop 1
v_max3_f32 v45, v240, v241, v242
v_max3_f32 v44, v44, v45, v243
v_mov_b32 v45, v44
s_nop 1
v_permlane32_swap_b32 v44, v45
v_max_f32 v44, v44, v45
v_mov_b32 v45, v44
s_nop 1
v_permlane16_swap_b32 v44, v45
v_max_f32 v44, v44, v45
v_mul_f32 v46, s68, v44
v_fma_f32 v228, v228, s68, -v46
v_fma_f32 v229, v229, s68, -v46
v_fma_f32 v230, v230, s68, -v46
v_fma_f32 v231, v231, s68, -v46
v_fma_f32 v232, v232, s68, -v46
v_fma_f32 v233, v233, s68, -v46
v_fma_f32 v234, v234, s68, -v46
v_fma_f32 v235, v235, s68, -v46
v_exp_f32 v228, v228
v_exp_f32 v229, v229
v_exp_f32 v230, v230
v_exp_f32 v231, v231
v_exp_f32 v232, v232
v_exp_f32 v233, v233
v_exp_f32 v234, v234
v_exp_f32 v235, v235
v_cvt_pk_bf16_f32 v244, v228, v229
v_cvt_pk_bf16_f32 v245, v230, v231
v_cvt_pk_bf16_f32 v246, v232, v233
v_cvt_pk_bf16_f32 v247, v234, v235
s_nop 1
v_mfma_f32_16x16x32_bf16 v[192:195], v[128:131], v[244:247], 0
v_mfma_f32_16x16x32_bf16 v[196:199], v[132:135], v[244:247], 0
v_mfma_f32_16x16x32_bf16 v[200:203], v[136:139], v[244:247], 0
v_mfma_f32_16x16x32_bf16 v[204:207], v[140:143], v[244:247], 0
v_mfma_f32_16x16x32_bf16 v[208:211], v[144:147], v[244:247], 0
v_mfma_f32_16x16x32_bf16 v[212:215], v[148:151], v[244:247], 0
v_mfma_f32_16x16x32_bf16 v[216:219], v[152:155], v[244:247], 0
v_mfma_f32_16x16x32_bf16 v[220:223], v[156:159], v[244:247], 0
v_mfma_f32_16x16x32_bf16 v[224:227], v[56:59], v[244:247], 0
v_fma_f32 v236, v236, s68, -v46
v_fma_f32 v237, v237, s68, -v46
v_fma_f32 v238, v238, s68, -v46
v_fma_f32 v239, v239, s68, -v46
v_fma_f32 v240, v240, s68, -v46
v_fma_f32 v241, v241, s68, -v46
v_fma_f32 v242, v242, s68, -v46
v_fma_f32 v243, v243, s68, -v46
v_exp_f32 v236, v236
v_exp_f32 v237, v237
v_exp_f32 v238, v238
v_exp_f32 v239, v239
v_exp_f32 v240, v240
v_exp_f32 v241, v241
v_exp_f32 v242, v242
v_exp_f32 v243, v243
v_cvt_pk_bf16_f32 v248, v236, v237
v_cvt_pk_bf16_f32 v249, v238, v239
v_cvt_pk_bf16_f32 v250, v240, v241
v_cvt_pk_bf16_f32 v251, v242, v243
s_cmp_eq_u32 s57, 0
s_cbranch_scc0 L_vs_28
s_cmp_eq_u32 s3, 0
s_cbranch_scc1 L_vs_28
s_cmp_lt_u32 s3, 4
s_cbranch_scc1 L_nrw_29
s_cmp_eq_u32 s96, 0
s_cbranch_scc1 L_rw_e_32
s_cmp_eq_u32 s96, 1
s_cbranch_scc0 L_rw_e_32
s_cmp_eq_u32 s96, 2
s_cbranch_scc1 L_rw_gu_30
v_lshrrev_b32 v50, 4, v1
v_and_b32 v50, 1, v50
v_lshlrev_b32 v50, 1, v50
v_and_b32 v51, 7, v1
v_xor_b32 v50, v50, v51
v_lshlrev_b32 v50, 4, v50
v_lshrrev_b32 v51, 3, v1
v_lshl_add_u32 v50, v51, 10, v50
v_xor_b32 v51, 64, v50
s_cmp_eq_u32 s96, 3
s_cbranch_scc1 L_rw_dn_31
s_lshl_b32 s84, s4, 19
s_lshl_b32 s85, s97, 7
s_add_u32 s84, s84, s85
s_sub_u32 s85, 0x400000, s84
s_add_u32 s48, s16, s84
s_addc_u32 s49, s17, 0
s_mov_b32 s50, s85
s_mov_b32 s51, 0x20000
s_lshl_b32 s84, s59, 17
s_lshl_b32 s86, s59, 14
s_add_u32 m0, s86, 73728
s_add_u32 s85, s84, 0
buffer_load_dwordx4 v50, s[48:51], s85 offen nt lds
s_add_u32 m0, s86, 74752
s_add_u32 s85, s84, 8192
buffer_load_dwordx4 v51, s[48:51], s85 offen nt lds
s_add_u32 m0, s86, 75776
s_add_u32 s85, s84, 16384
buffer_load_dwordx4 v50, s[48:51], s85 offen nt lds
s_add_u32 m0, s86, 76800
s_add_u32 s85, s84, 24576
buffer_load_dwordx4 v51, s[48:51], s85 offen nt lds
s_add_u32 m0, s86, 77824
s_add_u32 s85, s84, 32768
buffer_load_dwordx4 v50, s[48:51], s85 offen nt lds
s_add_u32 m0, s86, 78848
s_add_u32 s85, s84, 40960
buffer_load_dwordx4 v51, s[48:51], s85 offen nt lds
s_add_u32 m0, s86, 79872
s_add_u32 s85, s84, 49152
buffer_load_dwordx4 v50, s[48:51], s85 offen nt lds
s_add_u32 m0, s86, 80896
s_add_u32 s85, s84, 57344
buffer_load_dwordx4 v51, s[48:51], s85 offen nt lds
s_add_u32 m0, s86, 81920
s_add_u32 s85, s84, 65536
buffer_load_dwordx4 v50, s[48:51], s85 offen nt lds
s_add_u32 m0, s86, 82944
s_add_u32 s85, s84, 73728
buffer_load_dwordx4 v51, s[48:51], s85 offen nt lds
s_add_u32 m0, s86, 83968
s_add_u32 s85, s84, 81920
buffer_load_dwordx4 v50, s[48:51], s85 offen nt lds
s_add_u32 m0, s86, 84992
s_add_u32 s85, s84, 90112
buffer_load_dwordx4 v51, s[48:51], s85 offen nt lds
s_add_u32 m0, s86, 86016
s_add_u32 s85, s84, 98304
buffer_load_dwordx4 v50, s[48:51], s85 offen nt lds
s_add_u32 m0, s86, 87040
s_add_u32 s85, s84, 106496
buffer_load_dwordx4 v51, s[48:51], s85 offen nt lds
s_add_u32 m0, s86, 88064
s_add_u32 s85, s84, 114688
buffer_load_dwordx4 v50, s[48:51], s85 offen nt lds
s_add_u32 m0, s86, 89088
s_add_u32 s85, s84, 122880
buffer_load_dwordx4 v51, s[48:51], s85 offen nt lds
s_branch L_rw_e_32
L_rw_dn_31:
s_mul_i32 s84, s4, 229376
s_lshl_b32 s85, s97, 7
s_add_u32 s84, s84, s85
s_sub_u32 s85, 1835008, s84
s_add_u32 s48, s24, s84
s_addc_u32 s49, s25, 0
s_mov_b32 s50, s85
s_mov_b32 s51, 0x20000
s_lshl_b32 s84, s59, 16
s_lshl_b32 s86, s59, 13
s_add_u32 m0, s86, 73728
s_add_u32 s85, s84, 0
buffer_load_dwordx4 v50, s[48:51], s85 offen nt lds
s_add_u32 m0, s86, 74752
s_add_u32 s85, s84, 8192
buffer_load_dwordx4 v51, s[48:51], s85 offen nt lds
s_add_u32 m0, s86, 75776
s_add_u32 s85, s84, 16384
buffer_load_dwordx4 v50, s[48:51], s85 offen nt lds
s_add_u32 m0, s86, 76800
s_add_u32 s85, s84, 24576
buffer_load_dwordx4 v51, s[48:51], s85 offen nt lds
s_cmp_eq_u32 s59, 3
s_cbranch_scc1 L_rw_e_32
s_add_u32 m0, s86, 77824
s_add_u32 s85, s84, 32768
buffer_load_dwordx4 v50, s[48:51], s85 offen nt lds
s_add_u32 m0, s86, 78848
s_add_u32 s85, s84, 40960
buffer_load_dwordx4 v51, s[48:51], s85 offen nt lds
s_add_u32 m0, s86, 79872
s_add_u32 s85, s84, 49152
buffer_load_dwordx4 v50, s[48:51], s85 offen nt lds
s_add_u32 m0, s86, 80896
s_add_u32 s85, s84, 57344
buffer_load_dwordx4 v51, s[48:51], s85 offen nt lds
s_branch L_rw_e_32
L_rw_gu_30:
v_lshrrev_b32 v50, 5, v1
v_lshlrev_b32 v50, 1, v50
v_and_b32 v51, 3, v1
v_xor_b32 v50, v50, v51
v_lshlrev_b32 v50, 4, v50
v_lshrrev_b32 v51, 2, v1
v_mul_u32_u24 v51, 3584, v51
v_add_u32 v50, v50, v51
s_mul_i32 s84, s4, 448
s_lshl_b32 s85, s97, 6
s_add_u32 s84, s84, s85
s_sub_u32 s85, 1835008, s84
s_add_u32 s48, s20, s84
s_addc_u32 s49, s21, 0
s_mov_b32 s50, s85
s_mov_b32 s51, 0x20000
s_add_u32 s52, s22, s84
s_addc_u32 s53, s23, 0
s_mov_b32 s54, s85
s_mov_b32 s55, 0x20000
s_mul_i32 s84, s59, 458752
s_lshl_b32 s86, s59, 13
s_add_u32 m0, s86, 73728
s_add_u32 s85, s84, 0
buffer_load_dwordx4 v50, s[48:51], s85 offen nt lds
s_add_u32 m0, s86, 106496
s_nop 0
buffer_load_dwordx4 v50, s[52:55], s85 offen nt lds
s_add_u32 m0, s86, 74752
s_add_u32 s85, s84, 57344
buffer_load_dwordx4 v50, s[48:51], s85 offen nt lds
s_add_u32 m0, s86, 107520
s_nop 0
buffer_load_dwordx4 v50, s[52:55], s85 offen nt lds
s_add_u32 m0, s86, 75776
s_add_u32 s85, s84, 114688
buffer_load_dwordx4 v50, s[48:51], s85 offen nt lds
s_add_u32 m0, s86, 108544
s_nop 0
buffer_load_dwordx4 v50, s[52:55], s85 offen nt lds
s_add_u32 m0, s86, 76800
s_add_u32 s85, s84, 172032
buffer_load_dwordx4 v50, s[48:51], s85 offen nt lds
s_add_u32 m0, s86, 109568
s_nop 0
buffer_load_dwordx4 v50, s[52:55], s85 offen nt lds
s_add_u32 m0, s86, 77824
s_add_u32 s85, s84, 229376
buffer_load_dwordx4 v50, s[48:51], s85 offen nt lds
s_add_u32 m0, s86, 110592
s_nop 0
buffer_load_dwordx4 v50, s[52:55], s85 offen nt lds
s_add_u32 m0, s86, 78848
s_add_u32 s85, s84, 286720
buffer_load_dwordx4 v50, s[48:51], s85 offen nt lds
s_add_u32 m0, s86, 111616
s_nop 0
buffer_load_dwordx4 v50, s[52:55], s85 offen nt lds
s_add_u32 m0, s86, 79872
s_add_u32 s85, s84, 344064
buffer_load_dwordx4 v50, s[48:51], s85 offen nt lds
s_add_u32 m0, s86, 112640
s_nop 0
buffer_load_dwordx4 v50, s[52:55], s85 offen nt lds
s_add_u32 m0, s86, 80896
s_add_u32 s85, s84, 401408
buffer_load_dwordx4 v50, s[48:51], s85 offen nt lds
s_add_u32 m0, s86, 113664
s_nop 0
buffer_load_dwordx4 v50, s[52:55], s85 offen nt lds
L_rw_e_32:
L_nrw_29:
s_cmp_lt_u32 s3, 4
s_cbranch_scc1 L_v0_36
s_cmp_eq_u32 s96, 0
s_cbranch_scc1 L_v0_36
s_cmp_eq_u32 s96, 1
s_cbranch_scc1 L_v16_33
s_branch L_v0_36
s_cmp_eq_u32 s96, 3
s_cbranch_scc0 L_v16_33
s_cmp_eq_u32 s3, 7
s_cbranch_scc1 L_v4_35
s_waitcnt vmcnt(8)
s_branch L_vgo_37
L_v4_35:
s_waitcnt vmcnt(4)
s_branch L_vgo_37
L_v16_33:
s_waitcnt vmcnt(16)
s_branch L_vgo_37
L_v0_36:
s_waitcnt vmcnt(0)
L_vgo_37:
ds_read_b64_tr_b16 v[162:163], v42 offset:4096
v_xor_b32 v49, 32, v42
ds_read_b64_tr_b16 v[166:167], v49 offset:4096
v_xor_b32 v48, 64, v42
ds_read_b64_tr_b16 v[170:171], v48 offset:4096
v_xor_b32 v49, 96, v42
ds_read_b64_tr_b16 v[174:175], v49 offset:4096
v_xor_b32 v48, 128, v42
ds_read_b64_tr_b16 v[178:179], v48 offset:4096
v_xor_b32 v49, 160, v42
ds_read_b64_tr_b16 v[182:183], v49 offset:4096
v_xor_b32 v48, 192, v42
ds_read_b64_tr_b16 v[186:187], v48 offset:4096
v_xor_b32 v49, 224, v42
ds_read_b64_tr_b16 v[190:191], v49 offset:4096
s_waitcnt lgkmcnt(0)
L_vs_28:
s_nop 1
v_mfma_f32_16x16x32_bf16 v[192:195], v[160:163], v[248:251], v[192:195]
v_mfma_f32_16x16x32_bf16 v[196:199], v[164:167], v[248:251], v[196:199]
v_mfma_f32_16x16x32_bf16 v[200:203], v[168:171], v[248:251], v[200:203]
v_mfma_f32_16x16x32_bf16 v[204:207], v[172:175], v[248:251], v[204:207]
v_mfma_f32_16x16x32_bf16 v[208:211], v[176:179], v[248:251], v[208:211]
v_mfma_f32_16x16x32_bf16 v[212:215], v[180:183], v[248:251], v[212:215]
v_mfma_f32_16x16x32_bf16 v[216:219], v[184:187], v[248:251], v[216:219]
v_mfma_f32_16x16x32_bf16 v[220:223], v[188:191], v[248:251], v[220:223]
v_mfma_f32_16x16x32_bf16 v[224:227], v[56:59], v[248:251], v[224:227]
s_nop 0
v_mov_b32_dpp v192, v196 row_shr:4 row_mask:0xf bank_mask:0x2
v_mov_b32_dpp v193, v197 row_shr:4 row_mask:0xf bank_mask:0x2
v_mov_b32_dpp v194, v198 row_shr:4 row_mask:0xf bank_mask:0x2
v_mov_b32_dpp v195, v199 row_shr:4 row_mask:0xf bank_mask:0x2
v_mov_b32_dpp v192, v200 row_shr:8 row_mask:0xf bank_mask:0x4
v_mov_b32_dpp v193, v201 row_shr:8 row_mask:0xf bank_mask:0x4
v_mov_b32_dpp v194, v202 row_shr:8 row_mask:0xf bank_mask:0x4
v_mov_b32_dpp v195, v203 row_shr:8 row_mask:0xf bank_mask:0x4
v_mov_b32_dpp v192, v204 row_shr:12 row_mask:0xf bank_mask:0x8
v_mov_b32_dpp v193, v205 row_shr:12 row_mask:0xf bank_mask:0x8
v_mov_b32_dpp v194, v206 row_shr:12 row_mask:0xf bank_mask:0x8
v_mov_b32_dpp v195, v207 row_shr:12 row_mask:0xf bank_mask:0x8
ds_write_b128 v5, v[192:195] offset:0
v_mov_b32_dpp v208, v212 row_shr:4 row_mask:0xf bank_mask:0x2
v_mov_b32_dpp v209, v213 row_shr:4 row_mask:0xf bank_mask:0x2
v_mov_b32_dpp v210, v214 row_shr:4 row_mask:0xf bank_mask:0x2
v_mov_b32_dpp v211, v215 row_shr:4 row_mask:0xf bank_mask:0x2
v_mov_b32_dpp v208, v216 row_shr:8 row_mask:0xf bank_mask:0x4
v_mov_b32_dpp v209, v217 row_shr:8 row_mask:0xf bank_mask:0x4
v_mov_b32_dpp v210, v218 row_shr:8 row_mask:0xf bank_mask:0x4
v_mov_b32_dpp v211, v219 row_shr:8 row_mask:0xf bank_mask:0x4
v_mov_b32_dpp v208, v220 row_shr:12 row_mask:0xf bank_mask:0x8
v_mov_b32_dpp v209, v221 row_shr:12 row_mask:0xf bank_mask:0x8
v_mov_b32_dpp v210, v222 row_shr:12 row_mask:0xf bank_mask:0x8
v_mov_b32_dpp v211, v223 row_shr:12 row_mask:0xf bank_mask:0x8
ds_write_b128 v5, v[208:211] offset:256
s_mov_b64 exec, 0xf
v_mov_b32 v48, v46
v_mov_b32 v49, v224
ds_write_b64 v29, v[48:49]
s_mov_b64 exec, -1
s_setprio 0
s_waitcnt lgkmcnt(0)
s_barrier
v_mov_b32 v50, 156928
ds_read_b32 v51, v50
ds_read_b32 v52, v50 offset:20
ds_read_b64 v[200:201], v30 offset:0
ds_read_b64 v[202:203], v30 offset:32
ds_read_b64 v[204:205], v30 offset:64
ds_read_b64 v[206:207], v30 offset:96
ds_read_b64 v[208:209], v30 offset:128
ds_read_b64 v[210:211], v30 offset:160
ds_read_b64 v[212:213], v30 offset:192
ds_read_b64 v[214:215], v30 offset:224
ds_read_b32 v192, v6 offset:0
ds_read_b32 v193, v6 offset:8192
ds_read_b32 v194, v6 offset:16384
ds_read_b32 v195, v6 offset:24576
ds_read_b32 v196, v6 offset:32768
ds_read_b32 v197, v6 offset:40960
ds_read_b32 v198, v6 offset:49152
ds_read_b32 v199, v6 offset:57344
s_waitcnt lgkmcnt(8)
v_readfirstlane_b32 s56, v51
v_readfirstlane_b32 s80, v52
v_max3_f32 v44, v200, v202, v204
v_max3_f32 v44, v44, v206, v208
v_max3_f32 v44, v44, v210, v212
v_max_f32 v44, v44, v214
v_sub_f32 v200, v200, v44
v_sub_f32 v202, v202, v44
v_sub_f32 v204, v204, v44
v_sub_f32 v206, v206, v44
v_sub_f32 v208, v208, v44
v_sub_f32 v210, v210, v44
v_sub_f32 v212, v212, v44
v_sub_f32 v214, v214, v44
v_exp_f32 v200, v200
v_exp_f32 v202, v202
v_exp_f32 v204, v204
v_exp_f32 v206, v206
v_exp_f32 v208, v208
v_exp_f32 v210, v210
v_exp_f32 v212, v212
v_exp_f32 v214, v214
s_waitcnt lgkmcnt(0)
v_mul_f32 v48, v192, v200
v_mul_f32 v49, v201, v200
v_fmac_f32 v48, v193, v202
v_fmac_f32 v49, v203, v202
v_fmac_f32 v48, v194, v204
v_fmac_f32 v49, v205, v204
v_fmac_f32 v48, v195, v206
v_fmac_f32 v49, v207, v206
v_fmac_f32 v48, v196, v208
v_fmac_f32 v49, v209, v208
v_fmac_f32 v48, v197, v210
v_fmac_f32 v49, v211, v210
v_fmac_f32 v48, v198, v212
v_fmac_f32 v49, v213, v212
v_fmac_f32 v48, v199, v214
v_fmac_f32 v49, v215, v214
v_min_u32 v48, v43, v48
s_cmp_eq_u32 s56, 1
s_cbranch_scc1 L_gsf_38
buffer_store_dword v48, v8, s[40:43], s74 offen sc1
s_branch L_gse_39
L_gsf_38:
buffer_store_dword v48, v8, s[40:43], s74 offen
L_gse_39:
s_and_b32 s84, s3, 1
s_cmp_eq_u32 s84, 0
s_cbranch_scc0 L_nst_40
v_min_u32 v50, v43, v44
v_min_u32 v51, v43, v49
s_mul_i32 s84, s5, 2176
s_lshl_b32 s85, s3, 2
s_add_u32 s84, s84, s85
s_add_u32 s84, s84, 2048
v_mov_b32 v52, s84
s_mov_b64 exec, 1
s_cmp_eq_u32 s56, 1
s_cbranch_scc1 L_gsf_41
buffer_store_dwordx2 v[50:51], v52, s[40:43], s74 offen sc1
s_branch L_gse_42
L_gsf_41:
buffer_store_dwordx2 v[50:51], v52, s[40:43], s74 offen
L_gse_42:
s_mov_b64 exec, -1
L_nst_40:
s_cmp_eq_u32 s3, 0
s_cbranch_scc0 L_nh1_43
s_sleep 2
L_poll_44:
buffer_load_dwordx2 v[192:193], v18, s[40:43], s74 offen sc1
buffer_load_dwordx2 v[194:195], v18, s[40:43], s74 offen offset:2176 sc1
buffer_load_dwordx2 v[196:197], v19, s[40:43], s74 offen sc1
buffer_load_dwordx2 v[198:199], v19, s[40:43], s74 offen offset:2176 sc1
buffer_load_dwordx2 v[200:201], v20, s[40:43], s74 offen sc1
buffer_load_dwordx2 v[202:203], v20, s[40:43], s74 offen offset:2176 sc1
buffer_load_dwordx2 v[204:205], v21, s[40:43], s74 offen sc1
buffer_load_dwordx2 v[206:207], v21, s[40:43], s74 offen offset:2176 sc1
s_sub_u32 s58, s58, 1
s_cbranch_scc1 L_END
s_waitcnt vmcnt(0)
v_max3_u32 v44, v192, v193, v194
v_max3_u32 v44, v44, v195, v196
v_max3_u32 v44, v44, v197, v198
v_max3_u32 v44, v44, v199, v200
v_max3_u32 v44, v44, v201, v202
v_max3_u32 v44, v44, v203, v204
v_max3_u32 v44, v44, v205, v206
v_max_u32 v44, v44, v207
v_cmp_eq_u32 vcc, -1, v44
s_cbranch_vccnz L_poll_44
v_max3_f32 v44, v200, v202, v204
v_max_f32 v44, v44, v206
v_sub_f32 v200, v200, v44
v_sub_f32 v202, v202, v44
v_sub_f32 v204, v204, v44
v_sub_f32 v206, v206, v44
v_exp_f32 v200, v200
v_exp_f32 v202, v202
v_exp_f32 v204, v204
v_exp_f32 v206, v206
v_mul_f32 v45, v201, v200
v_mul_f32 v46, v192, v200
v_mul_f32 v47, v193, v200
v_fmac_f32 v45, v203, v202
v_fmac_f32 v46, v194, v202
v_fmac_f32 v47, v195, v202
v_fmac_f32 v45, v205, v204
v_fmac_f32 v46, v196, v204
v_fmac_f32 v47, v197, v204
v_fmac_f32 v45, v207, v206
v_fmac_f32 v46, v198, v206
v_fmac_f32 v47, v199, v206
v_rcp_f32 v45, v45
s_nop 0
v_mul_f32 v46, v46, v45
v_mul_f32 v47, v47, v45
v_cvt_pk_bf16_f32 v46, v46, v47
v_min_u32 v46, v43, v46
s_cmp_eq_u32 s56, 1
s_cbranch_scc1 L_gsf_45
buffer_store_dword v46, v22, s[40:43], s75 offen sc1
s_branch L_gse_46
L_gsf_45:
buffer_store_dword v46, v22, s[40:43], s75 offen
L_gse_46:
L_nh1_43:
s_cmp_lt_u32 s3, 4
s_cbranch_scc1 L_nwo0_47
s_waitcnt vmcnt(0)
s_cmp_eq_u32 s96, 1
s_cbranch_scc0 L_nwo0_47
s_mov_b64 exec, s[66:67]
v_mov_b32 v192, v56
v_mov_b32 v193, v56
v_mov_b32 v194, v56
v_mov_b32 v195, v56
v_mov_b32 v196, v56
v_mov_b32 v197, v56
v_mov_b32 v198, v56
v_mov_b32 v199, v56
v_mov_b32 v200, v56
v_mov_b32 v201, v56
v_mov_b32 v202, v56
v_mov_b32 v203, v56
v_mov_b32 v204, v56
v_mov_b32 v205, v56
v_mov_b32 v206, v56
v_mov_b32 v207, v56
s_mov_b64 exec, -1
ds_read_b64_tr_b16 v[208:209], v10 offset:0
ds_read_b64_tr_b16 v[210:211], v10 offset:512
ds_read_b64_tr_b16 v[212:213], v10 offset:4096
ds_read_b64_tr_b16 v[214:215], v10 offset:4608
ds_read_b64_tr_b16 v[216:217], v10 offset:8192
ds_read_b64_tr_b16 v[218:219], v10 offset:8704
ds_read_b64_tr_b16 v[220:221], v10 offset:12288
ds_read_b64_tr_b16 v[222:223], v10 offset:12800
v_xor_b32 v51, 32, v10
ds_read_b64_tr_b16 v[224:225], v51 offset:0
ds_read_b64_tr_b16 v[226:227], v51 offset:512
ds_read_b64_tr_b16 v[228:229], v51 offset:4096
ds_read_b64_tr_b16 v[230:231], v51 offset:4608
ds_read_b64_tr_b16 v[232:233], v51 offset:8192
ds_read_b64_tr_b16 v[234:235], v51 offset:8704
ds_read_b64_tr_b16 v[236:237], v51 offset:12288
ds_read_b64_tr_b16 v[238:239], v51 offset:12800
v_xor_b32 v50, 64, v10
ds_read_b64_tr_b16 v[12:13], v50 offset:0
ds_read_b64_tr_b16 v[14:15], v50 offset:512
ds_read_b64_tr_b16 v[16:17], v50 offset:4096
ds_read_b64_tr_b16 v[18:19], v50 offset:4608
ds_read_b64_tr_b16 v[20:21], v50 offset:8192
ds_read_b64_tr_b16 v[22:23], v50 offset:8704
ds_read_b64_tr_b16 v[24:25], v50 offset:12288
ds_read_b64_tr_b16 v[26:27], v50 offset:12800
L_nwo0_47:
s_barrier
s_cmp_lt_u32 s3, 4
s_cbranch_scc1 L_ngd_48
s_cmp_eq_u32 s57, 0
s_cbranch_scc0 L_ngd_48
s_cmp_eq_u32 s96, 0
s_cbranch_scc1 L_rw_e_51
s_cmp_eq_u32 s96, 1
s_cbranch_scc1 L_rw_e_51
s_cmp_eq_u32 s96, 2
s_cbranch_scc1 L_rw_gu_49
v_lshrrev_b32 v50, 4, v1
v_and_b32 v50, 1, v50
v_lshlrev_b32 v50, 1, v50
v_and_b32 v51, 7, v1
v_xor_b32 v50, v50, v51
v_lshlrev_b32 v50, 4, v50
v_lshrrev_b32 v51, 3, v1
v_lshl_add_u32 v50, v51, 10, v50
v_xor_b32 v51, 64, v50
s_cmp_eq_u32 s96, 3
s_cbranch_scc1 L_rw_dn_50
s_lshl_b32 s84, s4, 19
s_lshl_b32 s85, s97, 7
s_add_u32 s84, s84, s85
s_sub_u32 s85, 0x400000, s84
s_add_u32 s48, s16, s84
s_addc_u32 s49, s17, 0
s_mov_b32 s50, s85
s_mov_b32 s51, 0x20000
s_lshl_b32 s84, s59, 17
s_lshl_b32 s86, s59, 14
s_add_u32 m0, s86, 73728
s_add_u32 s85, s84, 0
buffer_load_dwordx4 v50, s[48:51], s85 offen nt lds
s_add_u32 m0, s86, 74752
s_add_u32 s85, s84, 8192
buffer_load_dwordx4 v51, s[48:51], s85 offen nt lds
s_add_u32 m0, s86, 75776
s_add_u32 s85, s84, 16384
buffer_load_dwordx4 v50, s[48:51], s85 offen nt lds
s_add_u32 m0, s86, 76800
s_add_u32 s85, s84, 24576
buffer_load_dwordx4 v51, s[48:51], s85 offen nt lds
s_add_u32 m0, s86, 77824
s_add_u32 s85, s84, 32768
buffer_load_dwordx4 v50, s[48:51], s85 offen nt lds
s_add_u32 m0, s86, 78848
s_add_u32 s85, s84, 40960
buffer_load_dwordx4 v51, s[48:51], s85 offen nt lds
s_add_u32 m0, s86, 79872
s_add_u32 s85, s84, 49152
buffer_load_dwordx4 v50, s[48:51], s85 offen nt lds
s_add_u32 m0, s86, 80896
s_add_u32 s85, s84, 57344
buffer_load_dwordx4 v51, s[48:51], s85 offen nt lds
s_add_u32 m0, s86, 81920
s_add_u32 s85, s84, 65536
buffer_load_dwordx4 v50, s[48:51], s85 offen nt lds
s_add_u32 m0, s86, 82944
s_add_u32 s85, s84, 73728
buffer_load_dwordx4 v51, s[48:51], s85 offen nt lds
s_add_u32 m0, s86, 83968
s_add_u32 s85, s84, 81920
buffer_load_dwordx4 v50, s[48:51], s85 offen nt lds
s_add_u32 m0, s86, 84992
s_add_u32 s85, s84, 90112
buffer_load_dwordx4 v51, s[48:51], s85 offen nt lds
s_add_u32 m0, s86, 86016
s_add_u32 s85, s84, 98304
buffer_load_dwordx4 v50, s[48:51], s85 offen nt lds
s_add_u32 m0, s86, 87040
s_add_u32 s85, s84, 106496
buffer_load_dwordx4 v51, s[48:51], s85 offen nt lds
s_add_u32 m0, s86, 88064
s_add_u32 s85, s84, 114688
buffer_load_dwordx4 v50, s[48:51], s85 offen nt lds
s_add_u32 m0, s86, 89088
s_add_u32 s85, s84, 122880
buffer_load_dwordx4 v51, s[48:51], s85 offen nt lds
s_branch L_rw_e_51
L_rw_dn_50:
s_mul_i32 s84, s4, 229376
s_lshl_b32 s85, s97, 7
s_add_u32 s84, s84, s85
s_sub_u32 s85, 1835008, s84
s_add_u32 s48, s24, s84
s_addc_u32 s49, s25, 0
s_mov_b32 s50, s85
s_mov_b32 s51, 0x20000
s_lshl_b32 s84, s59, 16
s_lshl_b32 s86, s59, 13
s_add_u32 m0, s86, 73728
s_add_u32 s85, s84, 0
buffer_load_dwordx4 v50, s[48:51], s85 offen nt lds
s_add_u32 m0, s86, 74752
s_add_u32 s85, s84, 8192
buffer_load_dwordx4 v51, s[48:51], s85 offen nt lds
s_add_u32 m0, s86, 75776
s_add_u32 s85, s84, 16384
buffer_load_dwordx4 v50, s[48:51], s85 offen nt lds
s_add_u32 m0, s86, 76800
s_add_u32 s85, s84, 24576
buffer_load_dwordx4 v51, s[48:51], s85 offen nt lds
s_cmp_eq_u32 s59, 3
s_cbranch_scc1 L_rw_e_51
s_add_u32 m0, s86, 77824
s_add_u32 s85, s84, 32768
buffer_load_dwordx4 v50, s[48:51], s85 offen nt lds
s_add_u32 m0, s86, 78848
s_add_u32 s85, s84, 40960
buffer_load_dwordx4 v51, s[48:51], s85 offen nt lds
s_add_u32 m0, s86, 79872
s_add_u32 s85, s84, 49152
buffer_load_dwordx4 v50, s[48:51], s85 offen nt lds
s_add_u32 m0, s86, 80896
s_add_u32 s85, s84, 57344
buffer_load_dwordx4 v51, s[48:51], s85 offen nt lds
s_branch L_rw_e_51
L_rw_gu_49:
v_lshrrev_b32 v50, 5, v1
v_lshlrev_b32 v50, 1, v50
v_and_b32 v51, 3, v1
v_xor_b32 v50, v50, v51
v_lshlrev_b32 v50, 4, v50
v_lshrrev_b32 v51, 2, v1
v_mul_u32_u24 v51, 3584, v51
v_add_u32 v50, v50, v51
s_mul_i32 s84, s4, 448
s_lshl_b32 s85, s97, 6
s_add_u32 s84, s84, s85
s_sub_u32 s85, 1835008, s84
s_add_u32 s48, s20, s84
s_addc_u32 s49, s21, 0
s_mov_b32 s50, s85
s_mov_b32 s51, 0x20000
s_add_u32 s52, s22, s84
s_addc_u32 s53, s23, 0
s_mov_b32 s54, s85
s_mov_b32 s55, 0x20000
s_mul_i32 s84, s59, 458752
s_lshl_b32 s86, s59, 13
s_add_u32 m0, s86, 73728
s_add_u32 s85, s84, 0
buffer_load_dwordx4 v50, s[48:51], s85 offen nt lds
s_add_u32 m0, s86, 106496
s_nop 0
buffer_load_dwordx4 v50, s[52:55], s85 offen nt lds
s_add_u32 m0, s86, 74752
s_add_u32 s85, s84, 57344
buffer_load_dwordx4 v50, s[48:51], s85 offen nt lds
s_add_u32 m0, s86, 107520
s_nop 0
buffer_load_dwordx4 v50, s[52:55], s85 offen nt lds
s_add_u32 m0, s86, 75776
s_add_u32 s85, s84, 114688
buffer_load_dwordx4 v50, s[48:51], s85 offen nt lds
s_add_u32 m0, s86, 108544
s_nop 0
buffer_load_dwordx4 v50, s[52:55], s85 offen nt lds
s_add_u32 m0, s86, 76800
s_add_u32 s85, s84, 172032
buffer_load_dwordx4 v50, s[48:51], s85 offen nt lds
s_add_u32 m0, s86, 109568
s_nop 0
buffer_load_dwordx4 v50, s[52:55], s85 offen nt lds
s_add_u32 m0, s86, 77824
s_add_u32 s85, s84, 229376
buffer_load_dwordx4 v50, s[48:51], s85 offen nt lds
s_add_u32 m0, s86, 110592
s_nop 0
buffer_load_dwordx4 v50, s[52:55], s85 offen nt lds
s_add_u32 m0, s86, 78848
s_add_u32 s85, s84, 286720
buffer_load_dwordx4 v50, s[48:51], s85 offen nt lds
s_add_u32 m0, s86, 111616
s_nop 0
buffer_load_dwordx4 v50, s[52:55], s85 offen nt lds
s_add_u32 m0, s86, 79872
s_add_u32 s85, s84, 344064
buffer_load_dwordx4 v50, s[48:51], s85 offen nt lds
s_add_u32 m0, s86, 112640
s_nop 0
buffer_load_dwordx4 v50, s[52:55], s85 offen nt lds
s_add_u32 m0, s86, 80896
s_add_u32 s85, s84, 401408
buffer_load_dwordx4 v50, s[48:51], s85 offen nt lds
s_add_u32 m0, s86, 113664
s_nop 0
buffer_load_dwordx4 v50, s[52:55], s85 offen nt lds
L_rw_e_51:
L_ngd_48:
s_cmp_lt_u32 s3, 4
s_cbranch_scc1 L_nwo2_52
s_cmp_eq_u32 s96, 1
s_cbranch_scc0 L_nwo2_52
L_poll_53:
s_mov_b64 exec, s[64:65]
buffer_load_dwordx4 v[192:195], v2, s[40:43], s75 offen offset:0 sc1
buffer_load_dwordx4 v[196:199], v2, s[40:43], s75 offen offset:512 sc1
buffer_load_dwordx4 v[200:203], v2, s[40:43], s75 offen offset:1024 sc1
buffer_load_dwordx4 v[204:207], v2, s[40:43], s75 offen offset:1536 sc1
s_mov_b64 exec, -1
s_sub_u32 s58, s58, 1
s_cbranch_scc1 L_END
s_waitcnt vmcnt(0)
v_max3_u32 v44, v192, v193, v194
v_max3_u32 v44, v44, v195, v196
v_max3_u32 v44, v44, v197, v198
v_max3_u32 v44, v44, v199, v200
v_max3_u32 v44, v44, v201, v202
v_max3_u32 v44, v44, v203, v204
v_max3_u32 v44, v44, v205, v206
v_max_u32 v44, v44, v207
v_cmp_eq_u32 vcc, -1, v44
s_cbranch_vccnz L_poll_53
s_waitcnt lgkmcnt(0)
v_mfma_f32_16x16x32_bf16 v[240:243], v[192:195], v[208:211], 0
v_mfma_f32_16x16x32_bf16 v[240:243], v[196:199], v[212:215], v[240:243]
v_mfma_f32_16x16x32_bf16 v[240:243], v[200:203], v[216:219], v[240:243]
v_mfma_f32_16x16x32_bf16 v[240:243], v[204:207], v[220:223], v[240:243]
v_xor_b32 v51, 96, v10
ds_read_b64_tr_b16 v[208:209], v51 offset:0
ds_read_b64_tr_b16 v[210:211], v51 offset:512
ds_read_b64_tr_b16 v[212:213], v51 offset:4096
ds_read_b64_tr_b16 v[214:215], v51 offset:4608
ds_read_b64_tr_b16 v[216:217], v51 offset:8192
ds_read_b64_tr_b16 v[218:219], v51 offset:8704
ds_read_b64_tr_b16 v[220:221], v51 offset:12288
ds_read_b64_tr_b16 v[222:223], v51 offset:12800
v_mfma_f32_16x16x32_bf16 v[244:247], v[192:195], v[224:227], 0
v_mfma_f32_16x16x32_bf16 v[244:247], v[196:199], v[228:231], v[244:247]
v_mfma_f32_16x16x32_bf16 v[244:247], v[200:203], v[232:235], v[244:247]
v_mfma_f32_16x16x32_bf16 v[244:247], v[204:207], v[236:239], v[244:247]
v_mfma_f32_16x16x32_bf16 v[248:251], v[192:195], v[12:15], 0
v_mfma_f32_16x16x32_bf16 v[248:251], v[196:199], v[16:19], v[248:251]
v_mfma_f32_16x16x32_bf16 v[248:251], v[200:203], v[20:23], v[248:251]
v_mfma_f32_16x16x32_bf16 v[248:251], v[204:207], v[24:27], v[248:251]
ds_write_b128 v9, v[240:243]
s_nop 2
ds_write_b128 v9, v[244:247] offset:1024
s_waitcnt lgkmcnt(2)
v_mfma_f32_16x16x32_bf16 v[252:255], v[192:195], v[208:211], 0
v_mfma_f32_16x16x32_bf16 v[252:255], v[196:199], v[212:215], v[252:255]
v_mfma_f32_16x16x32_bf16 v[252:255], v[200:203], v[216:219], v[252:255]
v_mfma_f32_16x16x32_bf16 v[252:255], v[204:207], v[220:223], v[252:255]
ds_write_b128 v9, v[248:251] offset:2048
s_nop 6
ds_write_b128 v9, v[252:255] offset:3072
s_waitcnt lgkmcnt(0)
L_nwo2_52:
s_barrier
s_cmp_eq_u32 s57, 0
s_cbranch_scc0 L_nop1_54
s_cmp_eq_u32 s96, 1
s_cbranch_scc1 L_nop1_54
s_cmp_eq_u32 s3, 2
s_cbranch_scc0 L_nop1_54
s_mul_i32 s84, s5, 2176
s_add_u32 s84, s84, 0x21000
v_lshlrev_b32 v50, 4, v1
buffer_load_dwordx4 v[60:63], v50, s[40:43], s84 offen sc1
buffer_load_dwordx4 v[60:63], v50, s[40:43], s84 offen offset:1024 sc1
buffer_load_dwordx4 v[60:63], v50, s[40:43], s84 offen offset:2048 sc1
s_lshr_b32 s85, s5, 3
s_cmp_eq_u32 s85, 1
s_cbranch_scc0 L_nop1_54
s_sub_u32 s84, s84, 17408
buffer_load_dwordx4 v[60:63], v50, s[40:43], s84 offen sc1
buffer_load_dwordx4 v[60:63], v50, s[40:43], s84 offen offset:1024 sc1
buffer_load_dwordx4 v[60:63], v50, s[40:43], s84 offen offset:2048 sc1
L_nop1_54:
s_cmp_lt_u32 s3, 4
s_cbranch_scc0 L_nwf_55
s_cmp_eq_u32 s96, 1
s_cbranch_scc0 L_wgate_57
s_cmp_eq_u32 s57, 1
s_cbranch_scc0 L_nunp_58
s_waitcnt vmcnt(0)
v_and_b32 v17, 0xffff0000, v16
v_lshlrev_b32 v16, 16, v16
L_nunp_58:
v_add_u32 v45, 16, v12
ds_read2st64_b32 v[192:193], v12 offset0:0 offset1:32
ds_read2st64_b32 v[194:195], v12 offset0:64 offset1:96
ds_read2st64_b32 v[196:197], v45 offset0:0 offset1:32
ds_read2st64_b32 v[198:199], v45 offset0:64 offset1:96
v_mov_b32 v201, s80
v_mov_b32 v203, s80
s_waitcnt lgkmcnt(0)
v_add_f32 v192, v192, v193
v_add_f32 v194, v194, v195
v_add_f32 v200, v192, v194
v_add_f32 v196, v196, v197
v_add_f32 v198, v198, v199
v_add_f32 v202, v196, v198
buffer_store_dwordx4 v[200:203], v13, s[44:47], s77 offen sc1
v_add_u32 v47, 4096, v26
s_sleep 10
L_arp_59:
buffer_load_dwordx4 v[204:207], v26, s[44:47], s77 offen offset:0 sc1
buffer_load_dwordx4 v[208:211], v26, s[44:47], s77 offen offset:1024 sc1
buffer_load_dwordx4 v[212:215], v26, s[44:47], s77 offen offset:2048 sc1
buffer_load_dwordx4 v[216:219], v26, s[44:47], s77 offen offset:3072 sc1
buffer_load_dwordx4 v[220:223], v47, s[44:47], s77 offen offset:0 sc1
buffer_load_dwordx4 v[224:227], v47, s[44:47], s77 offen offset:1024 sc1
buffer_load_dwordx4 v[228:231], v47, s[44:47], s77 offen offset:2048 sc1
buffer_load_dwordx4 v[232:235], v47, s[44:47], s77 offen offset:3072 sc1
s_sub_u32 s58, s58, 1
s_cbranch_scc1 L_END
s_waitcnt vmcnt(0)
v_min3_u32 v49, v205, v207, v209
v_max3_u32 v50, v205, v207, v209
v_min3_u32 v49, v49, v211, v213
v_max3_u32 v50, v50, v211, v213
v_min3_u32 v49, v49, v215, v217
v_max3_u32 v50, v50, v215, v217
v_min3_u32 v49, v49, v219, v221
v_max3_u32 v50, v50, v219, v221
v_min3_u32 v49, v49, v223, v225
v_max3_u32 v50, v50, v223, v225
v_min3_u32 v49, v49, v227, v229
v_max3_u32 v50, v50, v227, v229
v_min3_u32 v49, v49, v231, v233
v_max3_u32 v50, v50, v231, v233
v_min_u32 v49, v49, v235
v_max_u32 v50, v50, v235
v_xor_b32 v49, s80, v49
v_xor_b32 v50, s80, v50
v_or_b32 v49, v49, v50
v_cmp_ne_u32 vcc, 0, v49
s_cbranch_vccnz L_arp_59
v_add_f32 v236, v204, v208
v_add_f32 v238, v212, v216
v_add_f32 v240, v220, v224
v_add_f32 v242, v228, v232
v_add_f32 v237, v206, v210
v_add_f32 v239, v214, v218
v_add_f32 v241, v222, v226
v_add_f32 v243, v230, v234
v_add_f32 v236, v236, v238
v_add_f32 v240, v240, v242
v_add_f32 v237, v237, v239
v_add_f32 v241, v241, v243
v_add_f32 v236, v236, v240
v_add_f32 v237, v237, v241
v_cvt_pk_bf16_f32 v45, v236, v237
v_lshlrev_b32 v236, 16, v45
v_and_b32 v237, 0xffff0000, v45
v_add_f32 v236, v236, v16
v_add_f32 v237, v237, v17
v_cvt_pk_bf16_f32 v45, v236, v237
v_lshlrev_b32 v16, 16, v45
v_and_b32 v17, 0xffff0000, v45
v_min_u32 v45, v43, v45
s_cmp_eq_u32 s56, 1
s_cbranch_scc1 L_gsf_60
buffer_store_dword v45, v15, s[40:43], s79 offen sc1
s_branch L_gse_61
L_gsf_60:
buffer_store_dword v45, v15, s[40:43], s79 offen
L_gse_61:
s_branch L_nwf_55
L_wgate_57:
s_cmp_eq_u32 s96, 2
s_cbranch_scc0 L_nwf_55
L_nwf_55:
s_cmp_lt_u32 s3, 4
s_cbranch_scc1 L_ngp_63
s_cmp_eq_u32 s96, 2
s_cbranch_scc0 L_ngp_63
s_waitcnt vmcnt(0)
s_mov_b64 exec, s[66:67]
v_mov_b32 v192, v56
v_mov_b32 v193, v56
v_mov_b32 v194, v56
v_mov_b32 v195, v56
v_mov_b32 v196, v56
v_mov_b32 v197, v56
v_mov_b32 v198, v56
v_mov_b32 v199, v56
v_mov_b32 v200, v56
v_mov_b32 v201, v56
v_mov_b32 v202, v56
v_mov_b32 v203, v56
v_mov_b32 v204, v56
v_mov_b32 v205, v56
v_mov_b32 v206, v56
v_mov_b32 v207, v56
s_mov_b64 exec, -1
ds_read_b64_tr_b16 v[208:209], v10 offset:0
ds_read_b64_tr_b16 v[210:211], v10 offset:256
ds_read_b64_tr_b16 v[212:213], v10 offset:2048
ds_read_b64_tr_b16 v[214:215], v10 offset:2304
ds_read_b64_tr_b16 v[216:217], v10 offset:4096
ds_read_b64_tr_b16 v[218:219], v10 offset:4352
ds_read_b64_tr_b16 v[220:221], v10 offset:6144
ds_read_b64_tr_b16 v[222:223], v10 offset:6400
v_xor_b32 v51, 32, v10
ds_read_b64_tr_b16 v[224:225], v51 offset:0
ds_read_b64_tr_b16 v[226:227], v51 offset:256
ds_read_b64_tr_b16 v[228:229], v51 offset:2048
ds_read_b64_tr_b16 v[230:231], v51 offset:2304
ds_read_b64_tr_b16 v[232:233], v51 offset:4096
ds_read_b64_tr_b16 v[234:235], v51 offset:4352
ds_read_b64_tr_b16 v[236:237], v51 offset:6144
ds_read_b64_tr_b16 v[238:239], v51 offset:6400
ds_read_b64_tr_b16 v[12:13], v10 offset:32768
ds_read_b64_tr_b16 v[14:15], v10 offset:33024
ds_read_b64_tr_b16 v[16:17], v10 offset:34816
ds_read_b64_tr_b16 v[18:19], v10 offset:35072
ds_read_b64_tr_b16 v[20:21], v10 offset:36864
ds_read_b64_tr_b16 v[22:23], v10 offset:37120
ds_read_b64_tr_b16 v[24:25], v10 offset:38912
ds_read_b64_tr_b16 v[26:27], v10 offset:39168
L_ngp_63:
s_barrier
s_cmp_lt_u32 s3, 4
s_cbranch_scc1 L_ng_64
s_cmp_eq_u32 s96, 2
s_cbranch_scc0 L_ng_64
L_poll_65:
s_mov_b64 exec, s[64:65]
buffer_load_dwordx4 v[192:195], v2, s[40:43], s79 offen offset:0 sc1
buffer_load_dwordx4 v[196:199], v2, s[40:43], s79 offen offset:512 sc1
buffer_load_dwordx4 v[200:203], v2, s[40:43], s79 offen offset:1024 sc1
buffer_load_dwordx4 v[204:207], v2, s[40:43], s79 offen offset:1536 sc1
s_mov_b64 exec, -1
s_sub_u32 s58, s58, 1
s_cbranch_scc1 L_END
s_waitcnt vmcnt(0)
v_max3_u32 v44, v192, v193, v194
v_max3_u32 v44, v44, v195, v196
v_max3_u32 v44, v44, v197, v198
v_max3_u32 v44, v44, v199, v200
v_max3_u32 v44, v44, v201, v202
v_max3_u32 v44, v44, v203, v204
v_max3_u32 v44, v44, v205, v206
v_max_u32 v44, v44, v207
v_cmp_eq_u32 vcc, -1, v44
s_cbranch_vccnz L_poll_65
s_waitcnt lgkmcnt(0)
v_mfma_f32_16x16x32_bf16 v[240:243], v[192:195], v[208:211], 0
v_mfma_f32_16x16x32_bf16 v[240:243], v[196:199], v[212:215], v[240:243]
v_mfma_f32_16x16x32_bf16 v[240:243], v[200:203], v[216:219], v[240:243]
v_mfma_f32_16x16x32_bf16 v[240:243], v[204:207], v[220:223], v[240:243]
v_xor_b32 v51, 32, v10
ds_read_b64_tr_b16 v[208:209], v51 offset:32768
ds_read_b64_tr_b16 v[210:211], v51 offset:33024
ds_read_b64_tr_b16 v[212:213], v51 offset:34816
ds_read_b64_tr_b16 v[214:215], v51 offset:35072
ds_read_b64_tr_b16 v[216:217], v51 offset:36864
ds_read_b64_tr_b16 v[218:219], v51 offset:37120
ds_read_b64_tr_b16 v[220:221], v51 offset:38912
ds_read_b64_tr_b16 v[222:223], v51 offset:39168
v_mfma_f32_16x16x32_bf16 v[244:247], v[192:195], v[224:227], 0
v_mfma_f32_16x16x32_bf16 v[244:247], v[196:199], v[228:231], v[244:247]
v_mfma_f32_16x16x32_bf16 v[244:247], v[200:203], v[232:235], v[244:247]
v_mfma_f32_16x16x32_bf16 v[244:247], v[204:207], v[236:239], v[244:247]
v_mfma_f32_16x16x32_bf16 v[248:251], v[192:195], v[12:15], 0
v_mfma_f32_16x16x32_bf16 v[248:251], v[196:199], v[16:19], v[248:251]
v_mfma_f32_16x16x32_bf16 v[248:251], v[200:203], v[20:23], v[248:251]
v_mfma_f32_16x16x32_bf16 v[248:251], v[204:207], v[24:27], v[248:251]
v_mfma_f32_16x16x32_bf16 v[44:47], v[192:195], v[192:195], 0
v_mfma_f32_16x16x32_bf16 v[44:47], v[196:199], v[196:199], v[44:47]
v_mfma_f32_16x16x32_bf16 v[44:47], v[200:203], v[200:203], v[44:47]
v_mfma_f32_16x16x32_bf16 v[44:47], v[204:207], v[204:207], v[44:47]
ds_write_b128 v9, v[240:243]
ds_write_b128 v9, v[244:247] offset:1024
s_waitcnt lgkmcnt(2)
v_mfma_f32_16x16x32_bf16 v[252:255], v[192:195], v[208:211], 0
v_mfma_f32_16x16x32_bf16 v[252:255], v[196:199], v[212:215], v[252:255]
v_mfma_f32_16x16x32_bf16 v[252:255], v[200:203], v[216:219], v[252:255]
v_mfma_f32_16x16x32_bf16 v[252:255], v[204:207], v[220:223], v[252:255]
ds_write_b128 v9, v[248:251] offset:2048
ds_write_b128 v9, v[44:47] offset:4096
s_nop 5
ds_write_b128 v9, v[252:255] offset:3072
s_waitcnt lgkmcnt(0)
L_ng_64:
s_barrier
s_cmp_lt_u32 s3, 2
s_cbranch_scc0 L_ngf_66
s_cmp_eq_u32 s96, 2
s_cbranch_scc0 L_ngf_66
v_add_u32 v45, 16, v12
v_add_u32 v46, 16, v25
ds_read2st64_b32 v[224:225], v23 offset0:0 offset1:32
ds_read2st64_b32 v[226:227], v23 offset0:64 offset1:96
ds_read2st64_b32 v[228:229], v24 offset0:0 offset1:32
ds_read2st64_b32 v[230:231], v24 offset0:64 offset1:96
ds_read2st64_b32 v[192:193], v12 offset0:0 offset1:32
ds_read2st64_b32 v[194:195], v12 offset0:64 offset1:96
ds_read2st64_b32 v[196:197], v45 offset0:0 offset1:32
ds_read2st64_b32 v[198:199], v45 offset0:64 offset1:96
ds_read2st64_b32 v[200:201], v12 offset0:8 offset1:40
ds_read2st64_b32 v[202:203], v12 offset0:72 offset1:104
ds_read2st64_b32 v[204:205], v45 offset0:8 offset1:40
ds_read2st64_b32 v[206:207], v45 offset0:72 offset1:104
s_waitcnt lgkmcnt(8)
v_add_f32 v224, v224, v225
v_add_f32 v226, v226, v227
v_add_f32 v232, v224, v226
v_add_f32 v228, v228, v229
v_add_f32 v230, v230, v231
v_add_f32 v233, v228, v230
s_cmp_eq_u32 s57, 0
s_cbranch_scc0 L_cs_67
ds_read2st64_b32 v[208:209], v25 offset0:0 offset1:32
ds_read2st64_b32 v[210:211], v25 offset0:64 offset1:96
ds_read2st64_b32 v[212:213], v46 offset0:0 offset1:32
ds_read2st64_b32 v[214:215], v46 offset0:64 offset1:96
ds_read2st64_b32 v[216:217], v25 offset0:8 offset1:40
ds_read2st64_b32 v[218:219], v25 offset0:72 offset1:104
ds_read2st64_b32 v[220:221], v46 offset0:8 offset1:40
ds_read2st64_b32 v[222:223], v46 offset0:72 offset1:104
s_waitcnt lgkmcnt(0)
v_add_f32 v208, v208, v209
v_add_f32 v210, v210, v211
v_add_f32 v32, v208, v210
v_add_f32 v212, v212, v213
v_add_f32 v214, v214, v215
v_add_f32 v33, v212, v214
v_add_f32 v216, v216, v217
v_add_f32 v218, v218, v219
v_add_f32 v34, v216, v218
v_add_f32 v220, v220, v221
v_add_f32 v222, v222, v223
v_add_f32 v35, v220, v222
L_cs_67:
v_mul_f32 v232, s69, v232
v_mul_f32 v233, s69, v233
v_fma_f32 v233, -v232, v232, v233
v_max_f32 v233, 0, v233
v_add_f32 v233, s70, v233
v_rsq_f32 v233, v233
s_waitcnt lgkmcnt(0)
v_add_f32 v192, v192, v193
v_add_f32 v194, v194, v195
v_add_f32 v234, v192, v194
v_add_f32 v196, v196, v197
v_add_f32 v198, v198, v199
v_add_f32 v235, v196, v198
v_add_f32 v200, v200, v201
v_add_f32 v202, v202, v203
v_add_f32 v236, v200, v202
v_add_f32 v204, v204, v205
v_add_f32 v206, v206, v207
v_add_f32 v237, v204, v206
v_fma_f32 v234, -v232, v32, v234
v_fma_f32 v235, -v232, v33, v235
v_fma_f32 v236, -v232, v34, v236
v_fma_f32 v237, -v232, v35, v237
v_mul_f32 v234, v234, v233
v_mul_f32 v235, v235, v233
v_mul_f32 v236, v236, v233
v_mul_f32 v237, v237, v233
v_mul_f32 v234, s71, v234
v_mul_f32 v235, s71, v235
v_exp_f32 v234, v234
v_exp_f32 v235, v235
v_add_f32 v234, 1.0, v234
v_add_f32 v235, 1.0, v235
v_rcp_f32 v234, v234
v_rcp_f32 v235, v235
v_mul_f32 v234, v234, v236
v_mul_f32 v235, v235, v237
v_cvt_pk_bf16_f32 v45, v234, v235
v_min_u32 v45, v43, v45
s_cmp_eq_u32 s56, 1
s_cbranch_scc1 L_gsf_69
buffer_store_dword v45, v27, s[40:43], s76 offen sc1
s_branch L_gse_70
L_gsf_69:
buffer_store_dword v45, v27, s[40:43], s76 offen
L_gse_70:
L_ngf_66:
s_cmp_lt_u32 s3, 4
s_cbranch_scc1 L_nd_71
s_cmp_eq_u32 s96, 3
s_cbranch_scc0 L_nd_71
s_waitcnt vmcnt(0)
s_mov_b64 exec, s[66:67]
v_mov_b32 v192, v56
v_mov_b32 v193, v56
v_mov_b32 v194, v56
v_mov_b32 v195, v56
v_mov_b32 v196, v56
v_mov_b32 v197, v56
v_mov_b32 v198, v56
v_mov_b32 v199, v56
s_mov_b64 exec, -1
s_cmp_eq_u32 s3, 7
s_cbranch_scc1 L_nd1_72
ds_read_b64_tr_b16 v[208:209], v10 offset:0
ds_read_b64_tr_b16 v[210:211], v10 offset:512
ds_read_b64_tr_b16 v[212:213], v10 offset:4096
ds_read_b64_tr_b16 v[214:215], v10 offset:4608
v_xor_b32 v51, 32, v10
ds_read_b64_tr_b16 v[224:225], v51 offset:0
ds_read_b64_tr_b16 v[226:227], v51 offset:512
ds_read_b64_tr_b16 v[228:229], v51 offset:4096
ds_read_b64_tr_b16 v[230:231], v51 offset:4608
v_xor_b32 v50, 64, v10
ds_read_b64_tr_b16 v[12:13], v50 offset:0
ds_read_b64_tr_b16 v[14:15], v50 offset:512
ds_read_b64_tr_b16 v[16:17], v50 offset:4096
ds_read_b64_tr_b16 v[18:19], v50 offset:4608
s_sleep 8
L_poll_74:
s_mov_b64 exec, s[64:65]
buffer_load_dwordx4 v[192:195], v3, s[40:43], s76 offen offset:0 sc1
buffer_load_dwordx4 v[196:199], v3, s[40:43], s76 offen offset:512 sc1
s_mov_b64 exec, -1
s_sub_u32 s58, s58, 1
s_cbranch_scc1 L_END
s_waitcnt vmcnt(0)
v_max3_u32 v44, v192, v193, v194
v_max3_u32 v44, v44, v195, v196
v_max3_u32 v44, v44, v197, v198
v_max_u32 v44, v44, v199
v_cmp_eq_u32 vcc, -1, v44
s_cbranch_vccnz L_poll_74
s_waitcnt lgkmcnt(0)
v_mfma_f32_16x16x32_bf16 v[240:243], v[192:195], v[208:211], 0
v_mfma_f32_16x16x32_bf16 v[240:243], v[196:199], v[212:215], v[240:243]
v_xor_b32 v51, 96, v10
ds_read_b64_tr_b16 v[208:209], v51 offset:0
ds_read_b64_tr_b16 v[210:211], v51 offset:512
ds_read_b64_tr_b16 v[212:213], v51 offset:4096
ds_read_b64_tr_b16 v[214:215], v51 offset:4608
v_mfma_f32_16x16x32_bf16 v[244:247], v[192:195], v[224:227], 0
v_mfma_f32_16x16x32_bf16 v[244:247], v[196:199], v[228:231], v[244:247]
v_mfma_f32_16x16x32_bf16 v[248:251], v[192:195], v[12:15], 0
v_mfma_f32_16x16x32_bf16 v[248:251], v[196:199], v[16:19], v[248:251]
ds_write_b128 v9, v[240:243]
s_nop 4
ds_write_b128 v9, v[244:247] offset:1024
s_waitcnt lgkmcnt(2)
v_mfma_f32_16x16x32_bf16 v[252:255], v[192:195], v[208:211], 0
v_mfma_f32_16x16x32_bf16 v[252:255], v[196:199], v[212:215], v[252:255]
ds_write_b128 v9, v[248:251] offset:2048
s_nop 6
ds_write_b128 v9, v[252:255] offset:3072
s_waitcnt lgkmcnt(0)
s_branch L_nd_71
L_nd1_72:
ds_read_b64_tr_b16 v[208:209], v10 offset:0
ds_read_b64_tr_b16 v[210:211], v10 offset:512
v_xor_b32 v51, 32, v10
ds_read_b64_tr_b16 v[224:225], v51 offset:0
ds_read_b64_tr_b16 v[226:227], v51 offset:512
v_xor_b32 v50, 64, v10
ds_read_b64_tr_b16 v[12:13], v50 offset:0
ds_read_b64_tr_b16 v[14:15], v50 offset:512
s_sleep 8
L_poll_75:
s_mov_b64 exec, s[64:65]
buffer_load_dwordx4 v[192:195], v3, s[40:43], s76 offen offset:0 sc1
s_mov_b64 exec, -1
s_sub_u32 s58, s58, 1
s_cbranch_scc1 L_END
s_waitcnt vmcnt(0)
v_max3_u32 v44, v192, v193, v194
v_max_u32 v44, v44, v195
v_cmp_eq_u32 vcc, -1, v44
s_cbranch_vccnz L_poll_75
s_waitcnt lgkmcnt(0)
v_mfma_f32_16x16x32_bf16 v[240:243], v[192:195], v[208:211], 0
v_xor_b32 v51, 96, v10
ds_read_b64_tr_b16 v[208:209], v51 offset:0
ds_read_b64_tr_b16 v[210:211], v51 offset:512
v_mfma_f32_16x16x32_bf16 v[244:247], v[192:195], v[224:227], 0
v_mfma_f32_16x16x32_bf16 v[248:251], v[192:195], v[12:15], 0
s_nop 2
ds_write_b128 v9, v[240:243]
s_nop 2
ds_write_b128 v9, v[244:247] offset:1024
s_waitcnt lgkmcnt(2)
v_mfma_f32_16x16x32_bf16 v[252:255], v[192:195], v[208:211], 0
ds_write_b128 v9, v[248:251] offset:2048
s_nop 6
ds_write_b128 v9, v[252:255] offset:3072
s_waitcnt lgkmcnt(0)
L_nd_71:
s_cmp_lt_u32 s3, 4
s_cbranch_scc0 L_nres_76
s_cmp_eq_u32 s96, 3
s_cbranch_scc0 L_nres_76
L_resp_77:
buffer_load_dword v16, v15, s[40:43], s79 offen sc1
s_sub_u32 s58, s58, 1
s_cbranch_scc1 L_END
s_waitcnt vmcnt(0)
v_cmp_eq_u32 vcc, -1, v16
s_cbranch_vccnz L_resp_77
v_and_b32 v17, 0xffff0000, v16
v_lshlrev_b32 v16, 16, v16
L_nres_76:
s_barrier
s_cmp_lt_u32 s3, 4
s_cbranch_scc0 L_ndf_78
s_cmp_eq_u32 s96, 3
s_cbranch_scc0 L_dgate_80
v_add_u32 v45, 16, v12
ds_read2st64_b32 v[192:193], v12 offset0:0 offset1:32
ds_read2st64_b32 v[194:195], v12 offset0:64 offset1:96
ds_read2st64_b32 v[196:197], v45 offset0:0 offset1:32
ds_read2st64_b32 v[198:199], v45 offset0:64 offset1:96
v_mov_b32 v201, s80
v_mov_b32 v203, s80
s_waitcnt lgkmcnt(0)
v_add_f32 v192, v192, v193
v_add_f32 v194, v194, v195
v_add_f32 v200, v192, v194
v_add_f32 v196, v196, v197
v_add_f32 v198, v198, v199
v_add_f32 v202, v196, v198
buffer_store_dwordx4 v[200:203], v13, s[44:47], s78 offen sc1
v_add_u32 v47, 4096, v26
s_sleep 10
L_arp_81:
buffer_load_dwordx4 v[204:207], v26, s[44:47], s78 offen offset:0 sc1
buffer_load_dwordx4 v[208:211], v26, s[44:47], s78 offen offset:1024 sc1
buffer_load_dwordx4 v[212:215], v26, s[44:47], s78 offen offset:2048 sc1
buffer_load_dwordx4 v[216:219], v26, s[44:47], s78 offen offset:3072 sc1
buffer_load_dwordx4 v[220:223], v47, s[44:47], s78 offen offset:0 sc1
buffer_load_dwordx4 v[224:227], v47, s[44:47], s78 offen offset:1024 sc1
buffer_load_dwordx4 v[228:231], v47, s[44:47], s78 offen offset:2048 sc1
buffer_load_dwordx4 v[232:235], v47, s[44:47], s78 offen offset:3072 sc1
s_sub_u32 s58, s58, 1
s_cbranch_scc1 L_END
s_waitcnt vmcnt(0)
v_min3_u32 v49, v205, v207, v209
v_max3_u32 v50, v205, v207, v209
v_min3_u32 v49, v49, v211, v213
v_max3_u32 v50, v50, v211, v213
v_min3_u32 v49, v49, v215, v217
v_max3_u32 v50, v50, v215, v217
v_min3_u32 v49, v49, v219, v221
v_max3_u32 v50, v50, v219, v221
v_min3_u32 v49, v49, v223, v225
v_max3_u32 v50, v50, v223, v225
v_min3_u32 v49, v49, v227, v229
v_max3_u32 v50, v50, v227, v229
v_min3_u32 v49, v49, v231, v233
v_max3_u32 v50, v50, v231, v233
v_min_u32 v49, v49, v235
v_max_u32 v50, v50, v235
v_xor_b32 v49, s80, v49
v_xor_b32 v50, s80, v50
v_or_b32 v49, v49, v50
v_cmp_ne_u32 vcc, 0, v49
s_cbranch_vccnz L_arp_81
v_add_f32 v236, v204, v208
v_add_f32 v238, v212, v216
v_add_f32 v240, v220, v224
v_add_f32 v242, v228, v232
v_add_f32 v237, v206, v210
v_add_f32 v239, v214, v218
v_add_f32 v241, v222, v226
v_add_f32 v243, v230, v234
v_add_f32 v236, v236, v238
v_add_f32 v240, v240, v242
v_add_f32 v237, v237, v239
v_add_f32 v241, v241, v243
v_add_f32 v236, v236, v240
v_add_f32 v237, v237, v241
v_cvt_pk_bf16_f32 v45, v236, v237
v_lshlrev_b32 v236, 16, v45
v_and_b32 v237, 0xffff0000, v45
v_add_f32 v236, v236, v16
v_add_f32 v237, v237, v17
v_cvt_pk_bf16_f32 v45, v236, v237
v_lshlrev_b32 v16, 16, v45
v_and_b32 v17, 0xffff0000, v45
v_min_u32 v45, v43, v45
s_cmp_eq_u32 s57, 1
s_cbranch_scc1 L_last_82
s_mov_b32 s84, 0x6000
s_cmp_eq_u32 s56, 1
s_cbranch_scc1 L_gsf_84
buffer_store_dword v45, v15, s[40:43], s84 offen sc1
s_branch L_gse_85
L_gsf_84:
buffer_store_dword v45, v15, s[40:43], s84 offen
L_gse_85:
s_branch L_ndf2_83
L_last_82:
s_mov_b32 s48, s26
s_mov_b32 s49, s27
s_mov_b32 s50, 0x2000
s_mov_b32 s51, 0x20000
v_lshrrev_b32 v46, 3, v1
v_cmp_eq_u32 vcc, s4, v46
s_nop 0
s_and_saveexec_b64 s[84:85], vcc
buffer_store_dword v45, v7, s[48:51], 0 offen
s_mov_b64 exec, s[84:85]
L_ndf2_83:
s_branch L_ndf_78
L_dgate_80:
s_cmp_eq_u32 s57, 1
s_cbranch_scc1 L_ndf_78
s_mov_b32 s86, 0x6000
L_ndf_78:
s_cmp_eq_u32 s57, 1
s_cbranch_scc1 L_FIN
s_cmp_lt_u32 s3, 4
s_cbranch_scc1 L_nqp_86
s_mov_b64 exec, s[66:67]
v_mov_b32 v192, v56
v_mov_b32 v193, v56
v_mov_b32 v194, v56
v_mov_b32 v195, v56
v_mov_b32 v196, v56
v_mov_b32 v197, v56
v_mov_b32 v198, v56
v_mov_b32 v199, v56
v_mov_b32 v200, v56
v_mov_b32 v201, v56
v_mov_b32 v202, v56
v_mov_b32 v203, v56
v_mov_b32 v204, v56
v_mov_b32 v205, v56
v_mov_b32 v206, v56
v_mov_b32 v207, v56
s_mov_b64 exec, -1
ds_read_b64_tr_b16 v[208:209], v11 offset:0
ds_read_b64_tr_b16 v[210:211], v11 offset:128
ds_read_b64_tr_b16 v[212:213], v11 offset:1024
ds_read_b64_tr_b16 v[214:215], v11 offset:1152
ds_read_b64_tr_b16 v[216:217], v11 offset:2048
ds_read_b64_tr_b16 v[218:219], v11 offset:2176
ds_read_b64_tr_b16 v[220:221], v11 offset:3072
ds_read_b64_tr_b16 v[222:223], v11 offset:3200
L_nqp_86:
s_barrier
s_mov_b32 s57, 1
s_mov_b32 s73, 0x6000
s_mov_b32 s72, 0x2000
s_branch L_LAYER
L_FIN:
s_waitcnt vmcnt(0)
L_END:
s_endpgm
.section .rodata,"a"
.p2align 6
.amdhsa_kernel interleave_layers__sliding_block_cached__glu_gated_glu__decode_kernel
.amdhsa_next_free_vgpr 256
.amdhsa_next_free_sgpr 100
.amdhsa_accum_offset 256
.amdhsa_group_segment_fixed_size 0
.amdhsa_kernarg_size 96
.amdhsa_user_sgpr_count 2
.amdhsa_user_sgpr_kernarg_segment_ptr 1
.amdhsa_system_sgpr_workgroup_id_x 1
.end_amdhsa_kernel
```
